```python
import torch

def _softmax(x, axis=-1):
    return torch.softmax(x, dim=axis)
def _gelu(x):
    return torch.nn.functional.gelu(x, approximate="tanh")
def _silu(x):
    return torch.nn.functional.silu(x)
def _sigmoid(x):
    return torch.sigmoid(x)
def _layernorm(x, axis=-1, eps=1e-5):
    m = x.mean(dim=axis, keepdim=True)
    v = x.var(dim=axis, keepdim=True, unbiased=False)
    return (x - m) / torch.sqrt(v + eps)
def _scatter_add(tgt, idx, src, axis=0):
    return tgt.clone().index_add_(axis, idx, src)
def _segment_sum(src, seg, n):
    out = torch.zeros((n,) + src.shape[1:], dtype=src.dtype)
    return out.index_add_(0, seg, src)
def _pad(x, pw):
    flat = tuple(v for pair in reversed(pw) for v in pair)
    return torch.nn.functional.pad(x, flat)

kernel_name = 'recurrent_scan__sliding_block__mixer_s_mlp__prompt'

def setup_inputs():

    _w = (lambda a: (lambda t: t.to(torch.bfloat16) if t.is_floating_point() else t)(torch.as_tensor(a)))
    def _A_setup():
        B, S, D = 1, 2048, 512
        return {
            "x": _w((lambda *s: torch.randn(*s, dtype=torch.bfloat16) * 0.05)(B, S, D)),
            "wqkv": _w((lambda *s: torch.randn(*s, dtype=torch.bfloat16) * 0.05)(D, 3 * D)),
            "wo": _w((lambda *s: torch.randn(*s, dtype=torch.bfloat16) * 0.05)(D, D)),
        }
    _A_in = _A_setup()

    def _B_setup():
        B, S, D, F = 1, 2048, 512, 1792
        return {
            "x":  _w((lambda *s: torch.randn(*s, dtype=torch.bfloat16) * 0.05)(B, S, D)),
            "w1": _w((lambda *s: torch.randn(*s, dtype=torch.bfloat16) * 3.2)(D, D) * (D ** -0.5)),
            "w2": _w((lambda *s: torch.randn(*s, dtype=torch.bfloat16) * 3.2)(D, D) * (D ** -0.5)),
            "w3": _w((lambda *s: torch.randn(*s, dtype=torch.bfloat16) * 3.2)(D, F) * (D ** -0.5)),
            "w4": _w((lambda *s: torch.randn(*s, dtype=torch.bfloat16) * 1.6)(F, D) * (F ** -0.5)),
        }
    _B_in = _B_setup()

    return {
        "A_x": _A_in["x"],
        "A_wqkv": _A_in["wqkv"],
        "A_wo": _A_in["wo"],
        "B_x": _B_in["x"],
        "B_w1": _B_in["w1"],
        "B_w2": _B_in["w2"],
        "B_w3": _B_in["w3"],
        "B_w4": _B_in["w4"],
    }

def reference(A_x, A_wqkv, A_wo, B_x, B_w1, B_w2, B_w3, B_w4):
    def _A_ref(x, wqkv, wo):
        B, S, D = x.shape
        H = 32; Dh = D // H; W = 256
        qkv = (lambda x, *d: x.permute(*d))((x @ wqkv).reshape(B, S, 3, H, Dh), 2, 0, 3, 1, 4)
        q, k, v = qkv[0], qkv[1], qkv[2]
        scores = torch.einsum("bhqd,bhkd->bhqk", q, k) * (Dh ** -0.5)
        idx = torch.arange(S)
        mask = (idx[:, None] - idx[None, :] >= 0) & (idx[:, None] - idx[None, :] < W)
        scores = torch.where(mask[None, None], scores, -1e9)
        p = _softmax(scores, axis=-1)
        o = torch.einsum("bhqk,bhkd->bhqd", p, v)
        return (lambda x, *d: x.permute(*d))(o, 0, 2, 1, 3).reshape(B, S, D) @ wo

    def _B_ref(x, w1, w2, w3, w4):
        B, S, D = x.shape
        h = _gelu(_layernorm(x, axis=-1) @ w1)
        c = D // 4
        g0 = _pad(h[:, :, 0*c:1*c], ((0, 0), (1, 0), (0, 0)))[:, :S, :]
        g1 = _pad(h[:, :, 1*c:2*c], ((0, 0), (0, 1), (0, 0)))[:, 1:, :]
        g2 = _pad(h[:, :, 2*c:3*c], ((0, 0), (2, 0), (0, 0)))[:, :S, :]
        g3 = _pad(h[:, :, 3*c:   ], ((0, 0), (0, 2), (0, 0)))[:, 2:, :]
        hs = torch.concatenate([g0, g1, g2, g3], axis=-1) @ w2
        x1 = x + hs
        h2 = _gelu(_layernorm(x1, axis=-1) @ w3) @ w4
        return x1 + h2

    x = A_x
    xn = _layernorm(x, axis=-1)
    s = _A_ref(xn, A_wqkv, A_wo)
    g = _silu(_B_ref(xn, B_w1, B_w2, B_w3, B_w4))
    return x + s * g
```

```asm
; @launch kernel=kA_kernel grid=(256,1,1) block=(512,1,1) lds=135168
; @launch kernel=kB_kernel grid=(256,1,1) block=(768,1,1) lds=83008
; @launch kernel=kC_kernel grid=(256,1,1) block=(512,1,1) lds=133120
; @launch kernel=kD_kernel grid=(256,1,1) block=(256,1,1) lds=98304
.amdgcn_target "amdgcn-amd-amdhsa--gfx950"
.text
.globl kA_kernel
.p2align 8
.type kA_kernel,@function
kA_kernel:
    s_cmp_ge_u32 s2, 256
    s_cbranch_scc1 kA_done
    s_load_dwordx4 s[4:7], s[0:1], 0
    s_load_dwordx2 s[16:17], s[0:1], 32
    s_load_dwordx2 s[18:19], s[0:1], 48
    s_load_dwordx2 s[20:21], s[0:1], 72
    s_load_dwordx2 s[22:23], s[0:1], 80
    s_load_dwordx2 s[62:63], s[0:1], 40
    s_memrealtime s[64:65]
    s_and_b32 s24, s2, 7
    s_lshr_b32 s25, s2, 3
    v_readfirstlane_b32 s46, v0
    s_nop 0
    s_cmp_lt_u32 s46, 448
    s_cbranch_scc1 kA_1
    v_and_b32 v2, 63, v0
    s_getpc_b64 s[40:41]
cpf_2:
    s_sub_u32 s40, s40, cpf_2-kA_kernel
    s_subb_u32 s41, s41, 0
    s_lshl_b32 s42, s25, 13
    v_lshlrev_b32 v4, 7, v2
    v_add_u32 v4, s42, v4
    v_mov_b32 v5, text_end_marker-kA_kernel
    v_cmp_lt_u32 vcc, v4, v5
    s_and_saveexec_b64 s[44:45], vcc
    s_cbranch_execz cpf_3
    global_load_dword v20, v4, s[40:41]
cpf_3:
    s_mov_b64 exec, s[44:45]
kA_1:
    s_lshr_b32 s26, s24, 1
    s_lshl_b32 s26, s26, 2
    s_lshr_b32 s27, s25, 3
    s_add_u32 s26, s26, s27
    s_and_b32 s27, s24, 1
    s_lshl_b32 s27, s27, 3
    s_and_b32 s28, s25, 7
    s_add_u32 s27, s27, s28
    v_lshrrev_b32 v1, 6, v0
    v_and_b32 v2, 63, v0
    v_readfirstlane_b32 s33, v1
    s_lshr_b32 s37, s25, 3
    s_lshl_b32 s37, s37, 1
    s_add_u32 s37, s37, s25
    s_and_b32 s37, s37, 7
    s_cmp_lt_u32 s27, 12
    s_movk_i32 s34, 1024
    s_cselect_b32 s34, 3072, s34
    s_mov_b32 s14, 0x80000
    s_cselect_b32 s14, 0x180000, s14
    s_cselect_b32 s35, 0, 12
    s_sub_u32 s35, s27, s35
    s_lshl_b32 s35, s35, 8
    s_waitcnt lgkmcnt(0)
    s_cmp_lt_u32 s27, 12
    s_cselect_b32 s12, s6, s16
    s_cselect_b32 s13, s7, s17
    s_mov_b32 s15, 0x20000
    s_mov_b32 s8, s4
    s_mov_b32 s9, s5
    s_mov_b32 s10, 0x200000
    s_mov_b32 s11, 0x20000
    s_cmp_lt_u32 s33, 4
    s_cbranch_scc1 kA_compute
    s_sub_u32 s38, s33, 4
    v_and_b32 v4, 63, v0
    v_lshrrev_b32 v5, 3, v4
    v_lshlrev_b32 v5, 10, v5
    v_lshrrev_b32 v6, 4, v4
    v_and_b32 v8, 7, v4
    v_xor_b32 v8, v8, v6
    v_xor_b32 v9, 4, v8
    v_lshl_add_u32 v8, v8, 4, v5
    v_lshl_add_u32 v9, v9, 4, v5
    v_lshrrev_b32 v6, 4, v4
    v_lshlrev_b32 v5, 2, v6
    v_and_b32 v10, 15, v4
    v_xor_b32 v10, v10, v5
    v_lshlrev_b32 v10, 4, v10
    v_mul_lo_u32 v6, v6, s34
    v_add_u32 v10, v10, v6
    s_lshl_b32 s40, s26, 7
    s_lshl_b32 s41, s38, 5
    s_add_u32 s40, s40, s41
    s_lshl_b32 s40, s40, 10
    s_lshl_b32 s41, s38, 4
    s_mul_i32 s41, s41, s34
    s_add_u32 s41, s41, s35
    s_lshl_b32 s42, s34, 2
    s_lshl_b32 s43, s34, 6
    s_lshl_b32 s44, s38, 12
    s_lshl_b32 s45, s38, 12
    s_mul_i32 s47, s37, 128
    s_add_u32 s47, s47, s40
    s_mul_i32 s48, s37, s43
    s_add_u32 s48, s48, s41
    s_add_u32 m0, s44, 0
    s_mov_b32 s46, s47
    buffer_load_dwordx4 v8, s[8:11], s46 offen lds
    s_add_u32 m0, m0, 1024
    s_add_u32 s46, s46, 8192
    buffer_load_dwordx4 v9, s[8:11], s46 offen lds
    s_add_u32 m0, m0, 1024
    s_add_u32 s46, s46, 8192
    buffer_load_dwordx4 v8, s[8:11], s46 offen lds
    s_add_u32 m0, m0, 1024
    s_add_u32 s46, s46, 8192
    buffer_load_dwordx4 v9, s[8:11], s46 offen lds
    s_add_u32 m0, s45, 16384
    s_mov_b32 s46, s48
    buffer_load_dwordx4 v10, s[12:15], s46 offen lds
    s_add_u32 m0, m0, 1024
    s_add_u32 s46, s46, s42
    buffer_load_dwordx4 v10, s[12:15], s46 offen lds
    s_add_u32 m0, m0, 1024
    s_add_u32 s46, s46, s42
    buffer_load_dwordx4 v10, s[12:15], s46 offen lds
    s_add_u32 m0, m0, 1024
    s_add_u32 s46, s46, s42
    buffer_load_dwordx4 v10, s[12:15], s46 offen lds
    s_add_u32 s37, s37, 1
    s_and_b32 s37, s37, 7
    s_mul_i32 s47, s37, 128
    s_add_u32 s47, s47, s40
    s_mul_i32 s48, s37, s43
    s_add_u32 s48, s48, s41
    s_add_u32 m0, s44, 32768
    s_mov_b32 s46, s47
    buffer_load_dwordx4 v8, s[8:11], s46 offen lds
    s_add_u32 m0, m0, 1024
    s_add_u32 s46, s46, 8192
    buffer_load_dwordx4 v9, s[8:11], s46 offen lds
    s_add_u32 m0, m0, 1024
    s_add_u32 s46, s46, 8192
    buffer_load_dwordx4 v8, s[8:11], s46 offen lds
    s_add_u32 m0, m0, 1024
    s_add_u32 s46, s46, 8192
    buffer_load_dwordx4 v9, s[8:11], s46 offen lds
    s_add_u32 m0, s45, 49152
    s_mov_b32 s46, s48
    buffer_load_dwordx4 v10, s[12:15], s46 offen lds
    s_add_u32 m0, m0, 1024
    s_add_u32 s46, s46, s42
    buffer_load_dwordx4 v10, s[12:15], s46 offen lds
    s_add_u32 m0, m0, 1024
    s_add_u32 s46, s46, s42
    buffer_load_dwordx4 v10, s[12:15], s46 offen lds
    s_add_u32 m0, m0, 1024
    s_add_u32 s46, s46, s42
    buffer_load_dwordx4 v10, s[12:15], s46 offen lds
    s_add_u32 s37, s37, 1
    s_and_b32 s37, s37, 7
    s_waitcnt vmcnt(8)
    s_barrier
    s_mul_i32 s47, s37, 128
    s_add_u32 s47, s47, s40
    s_mul_i32 s48, s37, s43
    s_add_u32 s48, s48, s41
    s_add_u32 m0, s44, 65536
    s_mov_b32 s46, s47
    buffer_load_dwordx4 v8, s[8:11], s46 offen lds
    s_add_u32 m0, m0, 1024
    s_add_u32 s46, s46, 8192
    buffer_load_dwordx4 v9, s[8:11], s46 offen lds
    s_add_u32 m0, m0, 1024
    s_add_u32 s46, s46, 8192
    buffer_load_dwordx4 v8, s[8:11], s46 offen lds
    s_add_u32 m0, m0, 1024
    s_add_u32 s46, s46, 8192
    buffer_load_dwordx4 v9, s[8:11], s46 offen lds
    s_add_u32 m0, s45, 81920
    s_mov_b32 s46, s48
    buffer_load_dwordx4 v10, s[12:15], s46 offen lds
    s_add_u32 m0, m0, 1024
    s_add_u32 s46, s46, s42
    buffer_load_dwordx4 v10, s[12:15], s46 offen lds
    s_add_u32 m0, m0, 1024
    s_add_u32 s46, s46, s42
    buffer_load_dwordx4 v10, s[12:15], s46 offen lds
    s_add_u32 m0, m0, 1024
    s_add_u32 s46, s46, s42
    buffer_load_dwordx4 v10, s[12:15], s46 offen lds
    s_add_u32 s37, s37, 1
    s_and_b32 s37, s37, 7
    s_mul_i32 s47, s37, 128
    s_add_u32 s47, s47, s40
    s_mul_i32 s48, s37, s43
    s_add_u32 s48, s48, s41
    s_add_u32 m0, s44, 98304
    s_mov_b32 s46, s47
    buffer_load_dwordx4 v8, s[8:11], s46 offen lds
    s_add_u32 m0, m0, 1024
    s_add_u32 s46, s46, 8192
    buffer_load_dwordx4 v9, s[8:11], s46 offen lds
    s_add_u32 m0, m0, 1024
    s_add_u32 s46, s46, 8192
    buffer_load_dwordx4 v8, s[8:11], s46 offen lds
    s_add_u32 m0, m0, 1024
    s_add_u32 s46, s46, 8192
    buffer_load_dwordx4 v9, s[8:11], s46 offen lds
    s_add_u32 m0, s45, 114688
    s_mov_b32 s46, s48
    buffer_load_dwordx4 v10, s[12:15], s46 offen lds
    s_add_u32 m0, m0, 1024
    s_add_u32 s46, s46, s42
    buffer_load_dwordx4 v10, s[12:15], s46 offen lds
    s_add_u32 m0, m0, 1024
    s_add_u32 s46, s46, s42
    buffer_load_dwordx4 v10, s[12:15], s46 offen lds
    s_add_u32 m0, m0, 1024
    s_add_u32 s46, s46, s42
    buffer_load_dwordx4 v10, s[12:15], s46 offen lds
    s_add_u32 s37, s37, 1
    s_and_b32 s37, s37, 7
    s_waitcnt vmcnt(16)
    s_barrier
    s_mul_i32 s47, s37, 128
    s_add_u32 s47, s47, s40
    s_mul_i32 s48, s37, s43
    s_add_u32 s48, s48, s41
    s_add_u32 m0, s44, 0
    s_mov_b32 s46, s47
    buffer_load_dwordx4 v8, s[8:11], s46 offen lds
    s_add_u32 m0, m0, 1024
    s_add_u32 s46, s46, 8192
    buffer_load_dwordx4 v9, s[8:11], s46 offen lds
    s_add_u32 m0, m0, 1024
    s_add_u32 s46, s46, 8192
    buffer_load_dwordx4 v8, s[8:11], s46 offen lds
    s_add_u32 m0, m0, 1024
    s_add_u32 s46, s46, 8192
    buffer_load_dwordx4 v9, s[8:11], s46 offen lds
    s_add_u32 m0, s45, 16384
    s_mov_b32 s46, s48
    buffer_load_dwordx4 v10, s[12:15], s46 offen lds
    s_add_u32 m0, m0, 1024
    s_add_u32 s46, s46, s42
    buffer_load_dwordx4 v10, s[12:15], s46 offen lds
    s_add_u32 m0, m0, 1024
    s_add_u32 s46, s46, s42
    buffer_load_dwordx4 v10, s[12:15], s46 offen lds
    s_add_u32 m0, m0, 1024
    s_add_u32 s46, s46, s42
    buffer_load_dwordx4 v10, s[12:15], s46 offen lds
    s_add_u32 s37, s37, 1
    s_and_b32 s37, s37, 7
    s_waitcnt vmcnt(16)
    s_barrier
    s_mul_i32 s47, s37, 128
    s_add_u32 s47, s47, s40
    s_mul_i32 s48, s37, s43
    s_add_u32 s48, s48, s41
    s_add_u32 m0, s44, 32768
    s_mov_b32 s46, s47
    buffer_load_dwordx4 v8, s[8:11], s46 offen lds
    s_add_u32 m0, m0, 1024
    s_add_u32 s46, s46, 8192
    buffer_load_dwordx4 v9, s[8:11], s46 offen lds
    s_add_u32 m0, m0, 1024
    s_add_u32 s46, s46, 8192
    buffer_load_dwordx4 v8, s[8:11], s46 offen lds
    s_add_u32 m0, m0, 1024
    s_add_u32 s46, s46, 8192
    buffer_load_dwordx4 v9, s[8:11], s46 offen lds
    s_add_u32 m0, s45, 49152
    s_mov_b32 s46, s48
    buffer_load_dwordx4 v10, s[12:15], s46 offen lds
    s_add_u32 m0, m0, 1024
    s_add_u32 s46, s46, s42
    buffer_load_dwordx4 v10, s[12:15], s46 offen lds
    s_add_u32 m0, m0, 1024
    s_add_u32 s46, s46, s42
    buffer_load_dwordx4 v10, s[12:15], s46 offen lds
    s_add_u32 m0, m0, 1024
    s_add_u32 s46, s46, s42
    buffer_load_dwordx4 v10, s[12:15], s46 offen lds
    s_add_u32 s37, s37, 1
    s_and_b32 s37, s37, 7
    s_waitcnt vmcnt(16)
    s_barrier
    s_mul_i32 s47, s37, 128
    s_add_u32 s47, s47, s40
    s_mul_i32 s48, s37, s43
    s_add_u32 s48, s48, s41
    s_add_u32 m0, s44, 65536
    s_mov_b32 s46, s47
    buffer_load_dwordx4 v8, s[8:11], s46 offen lds
    s_add_u32 m0, m0, 1024
    s_add_u32 s46, s46, 8192
    buffer_load_dwordx4 v9, s[8:11], s46 offen lds
    s_add_u32 m0, m0, 1024
    s_add_u32 s46, s46, 8192
    buffer_load_dwordx4 v8, s[8:11], s46 offen lds
    s_add_u32 m0, m0, 1024
    s_add_u32 s46, s46, 8192
    buffer_load_dwordx4 v9, s[8:11], s46 offen lds
    s_add_u32 m0, s45, 81920
    s_mov_b32 s46, s48
    buffer_load_dwordx4 v10, s[12:15], s46 offen lds
    s_add_u32 m0, m0, 1024
    s_add_u32 s46, s46, s42
    buffer_load_dwordx4 v10, s[12:15], s46 offen lds
    s_add_u32 m0, m0, 1024
    s_add_u32 s46, s46, s42
    buffer_load_dwordx4 v10, s[12:15], s46 offen lds
    s_add_u32 m0, m0, 1024
    s_add_u32 s46, s46, s42
    buffer_load_dwordx4 v10, s[12:15], s46 offen lds
    s_add_u32 s37, s37, 1
    s_and_b32 s37, s37, 7
    s_waitcnt vmcnt(16)
    s_barrier
    s_mul_i32 s47, s37, 128
    s_add_u32 s47, s47, s40
    s_mul_i32 s48, s37, s43
    s_add_u32 s48, s48, s41
    s_add_u32 m0, s44, 98304
    s_mov_b32 s46, s47
    buffer_load_dwordx4 v8, s[8:11], s46 offen lds
    s_add_u32 m0, m0, 1024
    s_add_u32 s46, s46, 8192
    buffer_load_dwordx4 v9, s[8:11], s46 offen lds
    s_add_u32 m0, m0, 1024
    s_add_u32 s46, s46, 8192
    buffer_load_dwordx4 v8, s[8:11], s46 offen lds
    s_add_u32 m0, m0, 1024
    s_add_u32 s46, s46, 8192
    buffer_load_dwordx4 v9, s[8:11], s46 offen lds
    s_add_u32 m0, s45, 114688
    s_mov_b32 s46, s48
    buffer_load_dwordx4 v10, s[12:15], s46 offen lds
    s_add_u32 m0, m0, 1024
    s_add_u32 s46, s46, s42
    buffer_load_dwordx4 v10, s[12:15], s46 offen lds
    s_add_u32 m0, m0, 1024
    s_add_u32 s46, s46, s42
    buffer_load_dwordx4 v10, s[12:15], s46 offen lds
    s_add_u32 m0, m0, 1024
    s_add_u32 s46, s46, s42
    buffer_load_dwordx4 v10, s[12:15], s46 offen lds
    s_mov_b32 s28, s22
    s_mov_b32 s29, s23
    s_mov_b32 s30, 0x10000000
    s_mov_b32 s31, 0x20000
    v_and_b32 v12, 31, v2
    v_lshlrev_b32 v12, 4, v12
    s_lshl_b32 s56, s26, 7
    s_lshl_b32 s57, s38, 5
    s_add_u32 s56, s56, s57
    s_lshl_b32 s56, s56, 4
    s_add_u32 s56, s56, 0x1400000
    buffer_load_dwordx4 v[16:19], v12, s[28:31], s56 offen sc0 sc1
    v_and_b32 v13, 15, v2
    v_lshlrev_b32 v13, 4, v13
    v_lshrrev_b32 v14, 4, v2
    v_lshl_add_u32 v13, v14, 10, v13
    s_lshl_b32 s56, s27, 14
    s_lshl_b32 s57, s38, 8
    s_add_u32 s56, s56, s57
    s_add_u32 s56, s56, 0x1600000
    buffer_load_dwordx4 v[20:23], v13, s[28:31], s56 offen sc0 sc1
    s_add_u32 s56, s56, 4096
    buffer_load_dwordx4 v[24:27], v13, s[28:31], s56 offen sc0 sc1
    s_add_u32 s56, s56, 4096
    buffer_load_dwordx4 v[28:31], v13, s[28:31], s56 offen sc0 sc1
    s_add_u32 s56, s56, 4096
    buffer_load_dwordx4 v[32:35], v13, s[28:31], s56 offen sc0 sc1
    s_waitcnt vmcnt(21)
    s_barrier
    s_waitcnt vmcnt(13)
    s_barrier
    s_waitcnt vmcnt(5)
    s_barrier
    v_mov_b32 v40, 133632
    ds_read_b64 v[42:43], v40
    s_mov_b32 s61, 0x20000
kA_4:
    s_waitcnt vmcnt(0) lgkmcnt(0)
    v_xor_b32 v40, v42, v19
    v_xor_b32 v41, v43, v22
    v_or_b32 v40, v40, v41
    v_xor_b32 v41, v43, v26
    v_or_b32 v40, v40, v41
    v_xor_b32 v41, v43, v30
    v_or_b32 v40, v40, v41
    v_xor_b32 v41, v43, v34
    v_or_b32 v40, v40, v41
    v_cmp_ne_u32 vcc, 0, v40
    s_cbranch_vccz kA_5
    s_sub_u32 s61, s61, 1
    s_cmp_eq_u32 s61, 0
    s_cbranch_scc1 kA_5
    s_mov_b32 s28, s22
    s_mov_b32 s29, s23
    s_mov_b32 s30, 0x10000000
    s_mov_b32 s31, 0x20000
    v_and_b32 v12, 31, v2
    v_lshlrev_b32 v12, 4, v12
    s_lshl_b32 s56, s26, 7
    s_lshl_b32 s57, s38, 5
    s_add_u32 s56, s56, s57
    s_lshl_b32 s56, s56, 4
    s_add_u32 s56, s56, 0x1400000
    buffer_load_dwordx4 v[16:19], v12, s[28:31], s56 offen sc0 sc1
    v_and_b32 v13, 15, v2
    v_lshlrev_b32 v13, 4, v13
    v_lshrrev_b32 v14, 4, v2
    v_lshl_add_u32 v13, v14, 10, v13
    s_lshl_b32 s56, s27, 14
    s_lshl_b32 s57, s38, 8
    s_add_u32 s56, s56, s57
    s_add_u32 s56, s56, 0x1600000
    buffer_load_dwordx4 v[20:23], v13, s[28:31], s56 offen sc0 sc1
    s_add_u32 s56, s56, 4096
    buffer_load_dwordx4 v[24:27], v13, s[28:31], s56 offen sc0 sc1
    s_add_u32 s56, s56, 4096
    buffer_load_dwordx4 v[28:31], v13, s[28:31], s56 offen sc0 sc1
    s_add_u32 s56, s56, 4096
    buffer_load_dwordx4 v[32:35], v13, s[28:31], s56 offen sc0 sc1
    s_branch kA_4
kA_5:
    v_add_f32 v20, v20, v24
    v_add_f32 v21, v21, v25
    v_add_f32 v28, v28, v32
    v_add_f32 v29, v29, v33
    v_add_f32 v20, v20, v28
    v_add_f32 v21, v21, v29
    v_mov_b32 v22, v20
    v_mov_b32 v23, v21
    s_nop 1
    v_permlane16_swap_b32 v20, v22
    v_permlane16_swap_b32 v21, v23
    s_nop 0
    v_add_f32 v20, v20, v22
    v_add_f32 v21, v21, v23
    v_mov_b32 v22, v20
    v_mov_b32 v23, v21
    s_nop 1
    v_permlane32_swap_b32 v20, v22
    v_permlane32_swap_b32 v21, v23
    s_nop 0
    v_add_f32 v20, v20, v22
    v_add_f32 v21, v21, v23
    s_lshl_b32 s56, s38, 9
    s_add_u32 s56, s56, 131072
    v_add_u32 v12, s56, v12
    v_and_b32 v13, 15, v2
    v_lshlrev_b32 v13, 3, v13
    s_lshl_b32 s56, s38, 7
    s_add_u32 s56, s56, 133120
    v_add_u32 v13, s56, v13
    ds_write_b128 v12, v[16:19]
    ds_write_b64 v13, v[20:21]
    s_waitcnt lgkmcnt(0)
    s_barrier
    s_cmp_lg_u32 s38, 0
    s_cbranch_scc1 ld_6
    s_mov_b32 s28, s22
    s_mov_b32 s29, s23
    s_mov_b32 s30, 0x10000000
    s_mov_b32 s31, 0x20000
    s_mov_b32 s52, s18
    s_mov_b32 s53, s19
    s_mov_b32 s54, 0x1c0000
    s_mov_b32 s55, 0x20000
    s_lshl_b32 s56, s27, 8
    s_lshl_b32 s57, s26, 5
    s_mul_i32 s57, s57, 3584
    s_add_u32 s57, s57, s56
    v_lshrrev_b32 v12, 4, v2
    v_mul_u32_u24 v12, 3584, v12
    v_and_b32 v13, 15, v2
    v_lshl_add_u32 v12, v13, 4, v12
    s_movk_i32 s56, 14336
    buffer_load_dwordx4 v[16:19], v12, s[52:55], s57 offen
    s_add_u32 s57, s57, s56
    buffer_load_dwordx4 v[20:23], v12, s[52:55], s57 offen
    s_add_u32 s57, s57, s56
    buffer_load_dwordx4 v[24:27], v12, s[52:55], s57 offen
    s_add_u32 s57, s57, s56
    buffer_load_dwordx4 v[28:31], v12, s[52:55], s57 offen
    s_add_u32 s57, s57, s56
    buffer_load_dwordx4 v[32:35], v12, s[52:55], s57 offen
    s_add_u32 s57, s57, s56
    buffer_load_dwordx4 v[36:39], v12, s[52:55], s57 offen
    s_add_u32 s57, s57, s56
    buffer_load_dwordx4 v[40:43], v12, s[52:55], s57 offen
    s_add_u32 s57, s57, s56
    buffer_load_dwordx4 v[44:47], v12, s[52:55], s57 offen
    s_waitcnt vmcnt(0)
    v_mov_b32 v4, 0x3f80
    v_mov_b32 v5, 0x3f800000
    v_mov_b32 v48, 0
    v_mov_b32 v49, 0
    v_mov_b32 v50, 0
    v_mov_b32 v51, 0
    v_mov_b32 v52, 0
    v_mov_b32 v53, 0
    v_mov_b32 v54, 0
    v_mov_b32 v55, 0
    v_lshrrev_b32 v56, 4, v2
    v_cmp_eq_u32 s[50:51], 1, v56
    v_cmp_eq_u32 s[52:53], 2, v56
    v_cmp_eq_u32 s[54:55], 3, v56
    v_dot2_f32_bf16 v48, v16, v4, v48
    v_dot2_f32_bf16 v49, v16, v5, v49
    v_dot2_f32_bf16 v50, v17, v4, v50
    v_dot2_f32_bf16 v51, v17, v5, v51
    v_dot2_f32_bf16 v52, v18, v4, v52
    v_dot2_f32_bf16 v53, v18, v5, v53
    v_dot2_f32_bf16 v54, v19, v4, v54
    v_dot2_f32_bf16 v55, v19, v5, v55
    v_dot2_f32_bf16 v48, v20, v4, v48
    v_dot2_f32_bf16 v49, v20, v5, v49
    v_dot2_f32_bf16 v50, v21, v4, v50
    v_dot2_f32_bf16 v51, v21, v5, v51
    v_dot2_f32_bf16 v52, v22, v4, v52
    v_dot2_f32_bf16 v53, v22, v5, v53
    v_dot2_f32_bf16 v54, v23, v4, v54
    v_dot2_f32_bf16 v55, v23, v5, v55
    v_dot2_f32_bf16 v48, v24, v4, v48
    v_dot2_f32_bf16 v49, v24, v5, v49
    v_dot2_f32_bf16 v50, v25, v4, v50
    v_dot2_f32_bf16 v51, v25, v5, v51
    v_dot2_f32_bf16 v52, v26, v4, v52
    v_dot2_f32_bf16 v53, v26, v5, v53
    v_dot2_f32_bf16 v54, v27, v4, v54
    v_dot2_f32_bf16 v55, v27, v5, v55
    v_dot2_f32_bf16 v48, v28, v4, v48
    v_dot2_f32_bf16 v49, v28, v5, v49
    v_dot2_f32_bf16 v50, v29, v4, v50
    v_dot2_f32_bf16 v51, v29, v5, v51
    v_dot2_f32_bf16 v52, v30, v4, v52
    v_dot2_f32_bf16 v53, v30, v5, v53
    v_dot2_f32_bf16 v54, v31, v4, v54
    v_dot2_f32_bf16 v55, v31, v5, v55
    v_dot2_f32_bf16 v48, v32, v4, v48
    v_dot2_f32_bf16 v49, v32, v5, v49
    v_dot2_f32_bf16 v50, v33, v4, v50
    v_dot2_f32_bf16 v51, v33, v5, v51
    v_dot2_f32_bf16 v52, v34, v4, v52
    v_dot2_f32_bf16 v53, v34, v5, v53
    v_dot2_f32_bf16 v54, v35, v4, v54
    v_dot2_f32_bf16 v55, v35, v5, v55
    v_dot2_f32_bf16 v48, v36, v4, v48
    v_dot2_f32_bf16 v49, v36, v5, v49
    v_dot2_f32_bf16 v50, v37, v4, v50
    v_dot2_f32_bf16 v51, v37, v5, v51
    v_dot2_f32_bf16 v52, v38, v4, v52
    v_dot2_f32_bf16 v53, v38, v5, v53
    v_dot2_f32_bf16 v54, v39, v4, v54
    v_dot2_f32_bf16 v55, v39, v5, v55
    v_dot2_f32_bf16 v48, v40, v4, v48
    v_dot2_f32_bf16 v49, v40, v5, v49
    v_dot2_f32_bf16 v50, v41, v4, v50
    v_dot2_f32_bf16 v51, v41, v5, v51
    v_dot2_f32_bf16 v52, v42, v4, v52
    v_dot2_f32_bf16 v53, v42, v5, v53
    v_dot2_f32_bf16 v54, v43, v4, v54
    v_dot2_f32_bf16 v55, v43, v5, v55
    v_dot2_f32_bf16 v48, v44, v4, v48
    v_dot2_f32_bf16 v49, v44, v5, v49
    v_dot2_f32_bf16 v50, v45, v4, v50
    v_dot2_f32_bf16 v51, v45, v5, v51
    v_dot2_f32_bf16 v52, v46, v4, v52
    v_dot2_f32_bf16 v53, v46, v5, v53
    v_dot2_f32_bf16 v54, v47, v4, v54
    v_dot2_f32_bf16 v55, v47, v5, v55
    s_nop 2
    v_mov_b32 v56, v48
    v_mov_b32 v57, v49
    v_mov_b32 v58, v50
    v_mov_b32 v59, v51
    v_mov_b32 v60, v52
    v_mov_b32 v61, v53
    v_mov_b32 v62, v54
    v_mov_b32 v63, v55
    v_permlane16_swap_b32 v48, v56
    v_permlane16_swap_b32 v49, v57
    v_permlane16_swap_b32 v50, v58
    v_permlane16_swap_b32 v51, v59
    v_permlane16_swap_b32 v52, v60
    v_permlane16_swap_b32 v53, v61
    v_permlane16_swap_b32 v54, v62
    v_permlane16_swap_b32 v55, v63
    s_nop 0
    v_add_f32 v48, v48, v56
    v_add_f32 v49, v49, v57
    v_add_f32 v50, v50, v58
    v_add_f32 v51, v51, v59
    v_add_f32 v52, v52, v60
    v_add_f32 v53, v53, v61
    v_add_f32 v54, v54, v62
    v_add_f32 v55, v55, v63
    v_mov_b32 v56, v48
    v_mov_b32 v57, v49
    v_mov_b32 v58, v50
    v_mov_b32 v59, v51
    v_mov_b32 v60, v52
    v_mov_b32 v61, v53
    v_mov_b32 v62, v54
    v_mov_b32 v63, v55
    v_permlane32_swap_b32 v48, v56
    v_permlane32_swap_b32 v49, v57
    v_permlane32_swap_b32 v50, v58
    v_permlane32_swap_b32 v51, v59
    v_permlane32_swap_b32 v52, v60
    v_permlane32_swap_b32 v53, v61
    v_permlane32_swap_b32 v54, v62
    v_permlane32_swap_b32 v55, v63
    s_nop 0
    v_add_f32 v48, v48, v56
    v_add_f32 v49, v49, v57
    v_add_f32 v50, v50, v58
    v_add_f32 v51, v51, v59
    v_add_f32 v52, v52, v60
    v_add_f32 v53, v53, v61
    v_add_f32 v54, v54, v62
    v_add_f32 v55, v55, v63
    v_cndmask_b32 v48, v48, v50, s[50:51]
    v_cndmask_b32 v49, v49, v51, s[50:51]
    v_cndmask_b32 v48, v48, v52, s[52:53]
    v_cndmask_b32 v49, v49, v53, s[52:53]
    v_cndmask_b32 v48, v48, v54, s[54:55]
    v_cndmask_b32 v49, v49, v55, s[54:55]
    s_lshl_b32 s47, s27, 4
    s_add_u32 s47, s47, s26
    s_lshl_b32 s47, s47, 9
    s_add_u32 s47, s47, 0x1440000
    v_and_b32 v6, 15, v2
    v_lshrrev_b32 v7, 4, v2
    v_lshl_add_u32 v6, v6, 2, v7
    v_lshlrev_b32 v6, 3, v6
    buffer_store_dwordx2 v[48:49], v6, s[28:31], s47 offen
    s_endpgm
ld_6:
    s_cmp_eq_u32 s38, 3
    s_cbranch_scc1 kA_8
    s_mov_b32 s28, s22
    s_mov_b32 s29, s23
    s_mov_b32 s30, 0x10000000
    s_mov_b32 s31, 0x20000
    s_mul_i32 s56, s26, 16
    s_add_u32 s56, s56, s27
    s_lshr_b32 s57, s56, 5
    s_and_b32 s58, s56, 31
    s_lshl_b32 s59, s58, 14
    s_lshl_b32 s60, s57, 7
    s_add_u32 s59, s59, s60
    s_lshl_b32 s60, s57, 6
    s_add_u32 s60, s60, s58
    s_lshl_b32 s60, s60, 10
    s_lshl_b32 s56, s38, 11
    s_cmp_eq_u32 s38, 2
    s_cbranch_scc1 kA_9
    s_mov_b32 s52, s62
    s_mov_b32 s53, s63
    s_mov_b32 s54, 0x80000
    s_mov_b32 s55, 0x20000
    v_bfe_u32 v12, v2, 4, 1
    v_lshlrev_b32 v12, 2, v12
    v_and_b32 v13, 7, v2
    v_xor_b32 v12, v12, v13
    v_lshlrev_b32 v12, 4, v12
    v_lshrrev_b32 v13, 3, v2
    v_mul_u32_u24 v13, 1024, v13
    v_add_u32 v14, v13, v12
    v_bfe_u32 v12, v2, 4, 1
    v_lshlrev_b32 v12, 1, v12
    v_bfe_u32 v13, v2, 1, 1
    v_add_u32 v12, v12, v13
    v_bfe_u32 v13, v2, 3, 1
    v_lshlrev_b32 v13, 2, v13
    v_xor_b32 v12, v12, v13
    v_lshlrev_b32 v12, 4, v12
    v_and_b32 v13, 1, v2
    v_lshl_add_u32 v12, v13, 3, v12
    v_add_u32 v12, s56, v12
    v_lshrrev_b32 v13, 5, v2
    v_lshlrev_b32 v13, 2, v13
    v_bfe_u32 v16, v2, 2, 2
    v_add_u32 v13, v13, v16
    v_lshl_add_u32 v15, v13, 7, v12
    v_xor_b32 v16, 64, v15
    v_lshlrev_b32 v12, 4, v2
    s_add_u32 m0, s56, 0
    s_add_u32 s57, s59, 8192
    buffer_load_dwordx4 v14, s[52:55], s59 offen lds
    s_add_u32 m0, m0, 1024
    s_nop 0
    buffer_load_dwordx4 v14, s[52:55], s57 offen lds
    s_add_u32 s60, s60, 0x1700000
    s_add_u32 s61, s60, 32768
    s_waitcnt vmcnt(0)
    ds_read_b64_tr_b16 v[32:33], v15 offset:0
    ds_read_b64_tr_b16 v[34:35], v15 offset:1024
    ds_read_b64_tr_b16 v[36:37], v16 offset:0
    ds_read_b64_tr_b16 v[38:39], v16 offset:1024
    s_waitcnt lgkmcnt(0)
    buffer_store_dwordx4 v[32:35], v12, s[28:31], s60 offen
    buffer_store_dwordx4 v[36:39], v12, s[28:31], s61 offen
    s_branch kA_8
kA_9:
    s_load_dwordx2 s[52:53], s[0:1], 16
    s_waitcnt lgkmcnt(0)
    s_mov_b32 s54, 0x80000
    s_mov_b32 s55, 0x20000
    v_bfe_u32 v12, v2, 4, 1
    v_lshlrev_b32 v12, 2, v12
    v_and_b32 v13, 7, v2
    v_xor_b32 v12, v12, v13
    v_lshlrev_b32 v12, 4, v12
    v_lshrrev_b32 v13, 3, v2
    v_mul_u32_u24 v13, 1024, v13
    v_add_u32 v14, v13, v12
    v_bfe_u32 v12, v2, 4, 1
    v_lshlrev_b32 v12, 1, v12
    v_bfe_u32 v13, v2, 1, 1
    v_add_u32 v12, v12, v13
    v_bfe_u32 v13, v2, 3, 1
    v_lshlrev_b32 v13, 2, v13
    v_xor_b32 v12, v12, v13
    v_lshlrev_b32 v12, 4, v12
    v_and_b32 v13, 1, v2
    v_lshl_add_u32 v12, v13, 3, v12
    v_add_u32 v12, s56, v12
    v_lshrrev_b32 v13, 5, v2
    v_lshlrev_b32 v13, 3, v13
    v_bfe_u32 v16, v2, 2, 2
    v_add_u32 v13, v13, v16
    v_lshl_add_u32 v15, v13, 7, v12
    v_xor_b32 v16, 64, v15
    v_lshlrev_b32 v12, 4, v2
    s_add_u32 m0, s56, 0
    s_add_u32 s57, s59, 8192
    buffer_load_dwordx4 v14, s[52:55], s59 offen lds
    s_add_u32 m0, m0, 1024
    s_nop 0
    buffer_load_dwordx4 v14, s[52:55], s57 offen lds
    s_add_u32 s60, s60, 0x1780000
    s_add_u32 s61, s60, 32768
    s_waitcnt vmcnt(0)
    ds_read_b64_tr_b16 v[32:33], v15 offset:0
    ds_read_b64_tr_b16 v[34:35], v15 offset:512
    ds_read_b64_tr_b16 v[36:37], v16 offset:0
    ds_read_b64_tr_b16 v[38:39], v16 offset:512
    s_waitcnt lgkmcnt(0)
    buffer_store_dwordx4 v[32:35], v12, s[28:31], s60 offen
    buffer_store_dwordx4 v[36:39], v12, s[28:31], s61 offen
kA_8:
    s_endpgm
ld_7:
kA_compute:
    s_mov_b32 s28, s22
    s_mov_b32 s29, s23
    s_mov_b32 s30, 0x10000000
    s_mov_b32 s31, 0x20000
    v_lshlrev_b32 v3, 2, v2
    s_or_b32 s64, s64, 1
    s_cmp_lg_u32 s33, 0
    s_cbranch_scc1 kA_11
    v_mov_b32 v4, s64
    s_mov_b64 s[48:49], exec
    s_mov_b64 exec, 1
    s_cmp_lg_u32 s27, 0
    s_cbranch_scc1 kA_10
    s_lshl_b32 s46, s26, 2
    v_mov_b32 v5, s46
    global_store_dword v5, v4, s[20:21] sc0 sc1
kA_10:
    s_cmp_lg_u32 s26, 0
    s_cbranch_scc1 kA_12
    s_lshl_b32 s46, s27, 2
    s_add_u32 s46, s46, 64
    v_mov_b32 v5, s46
    global_store_dword v5, v4, s[20:21] sc0 sc1
kA_12:
    s_mov_b64 exec, s[48:49]
kA_11:
kA_w1:
    s_cmp_ge_u32 s33, 2
    s_cbranch_scc1 kA_13
    s_lshl_b32 s47, s26, 5
    s_mul_i32 s47, s47, s34
    s_add_u32 s47, s47, s35
    s_lshl_b32 s46, s33, 7
    s_add_u32 s47, s47, s46
    v_lshrrev_b32 v6, 3, v2
    v_mul_lo_u32 v6, v6, s34
    v_and_b32 v7, 7, v2
    v_lshl_add_u32 v6, v7, 4, v6
    s_lshl_b32 s46, s34, 3
    buffer_load_dwordx4 v[152:155], v6, s[12:15], s47 offen
    s_add_u32 s47, s47, s46
    buffer_load_dwordx4 v[156:159], v6, s[12:15], s47 offen
    s_add_u32 s47, s47, s46
    buffer_load_dwordx4 v[160:163], v6, s[12:15], s47 offen
    s_add_u32 s47, s47, s46
    buffer_load_dwordx4 v[164:167], v6, s[12:15], s47 offen
    s_branch kA_14
kA_13:
    s_lshl_b32 s61, s26, 7
    s_lshl_b32 s46, s27, 3
    s_add_u32 s61, s61, s46
    s_sub_u32 s46, s33, 2
    s_lshl_b32 s46, s46, 2
    s_add_u32 s61, s61, s46
    s_lshl_b32 s46, s61, 10
    v_lshlrev_b32 v6, 4, v2
    buffer_load_dwordx4 v[152:155], v6, s[8:11], s46 offen offset:0
    buffer_load_dwordx4 v[156:159], v6, s[8:11], s46 offen offset:1024
    buffer_load_dwordx4 v[160:163], v6, s[8:11], s46 offen offset:2048
    buffer_load_dwordx4 v[164:167], v6, s[8:11], s46 offen offset:3072
kA_14:
    s_lshr_b32 s38, s33, 1
    s_and_b32 s39, s33, 1
    v_and_b32 v4, 63, v0
    v_and_b32 v5, 31, v4
    v_lshrrev_b32 v6, 5, v4
    v_bfe_u32 v7, v4, 1, 3
    v_xor_b32 v6, v6, v7
    v_lshlrev_b32 v5, 7, v5
    s_lshl_b32 s90, s38, 13
    v_add_u32 v5, s90, v5
    v_xor_b32 v8, 0, v6
    v_lshl_add_u32 v8, v8, 4, v5
    v_xor_b32 v9, 2, v6
    v_lshl_add_u32 v9, v9, 4, v5
    v_xor_b32 v10, 4, v6
    v_lshl_add_u32 v10, v10, 4, v5
    v_xor_b32 v11, 6, v6
    v_lshl_add_u32 v11, v11, 4, v5
    v_bfe_u32 v5, v4, 2, 2
    v_lshrrev_b32 v6, 5, v4
    v_lshlrev_b32 v6, 3, v6
    v_add_u32 v6, v6, v5
    v_lshlrev_b32 v6, 8, v6
    v_bfe_u32 v7, v4, 4, 1
    v_lshlrev_b32 v7, 1, v7
    v_bfe_u32 v12, v4, 1, 1
    v_add_u32 v7, v7, v12
    s_lshl_b32 s90, s39, 3
    v_add_u32 v7, s90, v7
    v_lshlrev_b32 v5, 2, v5
    v_xor_b32 v7, v7, v5
    v_xor_b32 v5, 4, v7
    v_and_b32 v4, 1, v4
    v_lshl_add_u32 v6, v4, 3, v6
    v_add_u32 v6, 16384, v6
    v_lshl_add_u32 v12, v7, 4, v6
    v_lshl_add_u32 v13, v5, 4, v6
    s_mov_b32 s60, 0
    s_cmp_ge_u32 s33, 2
    s_cbranch_scc1 kA_15
    s_waitcnt vmcnt(0)
    s_cmp_lg_u32 s33, 0
    s_cbranch_scc1 kA_16
    global_load_dword v49, v3, s[20:21] sc0 sc1
kA_16:
    v_mov_b32 v4, 0x3f80
    v_mov_b32 v5, 0x3f800000
    v_mov_b32 v184, 0
    v_mov_b32 v185, 0
    v_mov_b32 v186, 0
    v_mov_b32 v187, 0
    v_mov_b32 v188, 0
    v_mov_b32 v189, 0
    v_mov_b32 v190, 0
    v_mov_b32 v191, 0
    v_bfe_u32 v192, v2, 3, 2
    v_cmp_eq_u32 s[50:51], 1, v192
    v_cmp_eq_u32 s[52:53], 2, v192
    v_cmp_eq_u32 s[54:55], 3, v192
    v_dot2_f32_bf16 v184, v152, v4, v184
    v_dot2_f32_bf16 v185, v152, v5, v185
    v_dot2_f32_bf16 v186, v153, v4, v186
    v_dot2_f32_bf16 v187, v153, v5, v187
    v_dot2_f32_bf16 v188, v154, v4, v188
    v_dot2_f32_bf16 v189, v154, v5, v189
    v_dot2_f32_bf16 v190, v155, v4, v190
    v_dot2_f32_bf16 v191, v155, v5, v191
    v_dot2_f32_bf16 v184, v156, v4, v184
    v_dot2_f32_bf16 v185, v156, v5, v185
    v_dot2_f32_bf16 v186, v157, v4, v186
    v_dot2_f32_bf16 v187, v157, v5, v187
    v_dot2_f32_bf16 v188, v158, v4, v188
    v_dot2_f32_bf16 v189, v158, v5, v189
    v_dot2_f32_bf16 v190, v159, v4, v190
    v_dot2_f32_bf16 v191, v159, v5, v191
    v_dot2_f32_bf16 v184, v160, v4, v184
    v_dot2_f32_bf16 v185, v160, v5, v185
    v_dot2_f32_bf16 v186, v161, v4, v186
    v_dot2_f32_bf16 v187, v161, v5, v187
    v_dot2_f32_bf16 v188, v162, v4, v188
    v_dot2_f32_bf16 v189, v162, v5, v189
    v_dot2_f32_bf16 v190, v163, v4, v190
    v_dot2_f32_bf16 v191, v163, v5, v191
    v_dot2_f32_bf16 v184, v164, v4, v184
    v_dot2_f32_bf16 v185, v164, v5, v185
    v_dot2_f32_bf16 v186, v165, v4, v186
    v_dot2_f32_bf16 v187, v165, v5, v187
    v_dot2_f32_bf16 v188, v166, v4, v188
    v_dot2_f32_bf16 v189, v166, v5, v189
    v_dot2_f32_bf16 v190, v167, v4, v190
    v_dot2_f32_bf16 v191, v167, v5, v191
    s_nop 2
    v_add_f32_dpp v184, v184, v184 row_ror:8 row_mask:0xf bank_mask:0xf
    v_add_f32_dpp v185, v185, v185 row_ror:8 row_mask:0xf bank_mask:0xf
    v_add_f32_dpp v186, v186, v186 row_ror:8 row_mask:0xf bank_mask:0xf
    v_add_f32_dpp v187, v187, v187 row_ror:8 row_mask:0xf bank_mask:0xf
    v_add_f32_dpp v188, v188, v188 row_ror:8 row_mask:0xf bank_mask:0xf
    v_add_f32_dpp v189, v189, v189 row_ror:8 row_mask:0xf bank_mask:0xf
    v_add_f32_dpp v190, v190, v190 row_ror:8 row_mask:0xf bank_mask:0xf
    v_add_f32_dpp v191, v191, v191 row_ror:8 row_mask:0xf bank_mask:0xf
    v_mov_b32 v192, v184
    v_mov_b32 v193, v185
    v_mov_b32 v194, v186
    v_mov_b32 v195, v187
    v_mov_b32 v196, v188
    v_mov_b32 v197, v189
    v_mov_b32 v198, v190
    v_mov_b32 v199, v191
    v_permlane16_swap_b32 v184, v192
    v_permlane16_swap_b32 v185, v193
    v_permlane16_swap_b32 v186, v194
    v_permlane16_swap_b32 v187, v195
    v_permlane16_swap_b32 v188, v196
    v_permlane16_swap_b32 v189, v197
    v_permlane16_swap_b32 v190, v198
    v_permlane16_swap_b32 v191, v199
    s_nop 0
    v_add_f32 v184, v184, v192
    v_add_f32 v185, v185, v193
    v_add_f32 v186, v186, v194
    v_add_f32 v187, v187, v195
    v_add_f32 v188, v188, v196
    v_add_f32 v189, v189, v197
    v_add_f32 v190, v190, v198
    v_add_f32 v191, v191, v199
    v_mov_b32 v192, v184
    v_mov_b32 v193, v185
    v_mov_b32 v194, v186
    v_mov_b32 v195, v187
    v_mov_b32 v196, v188
    v_mov_b32 v197, v189
    v_mov_b32 v198, v190
    v_mov_b32 v199, v191
    v_permlane32_swap_b32 v184, v192
    v_permlane32_swap_b32 v185, v193
    v_permlane32_swap_b32 v186, v194
    v_permlane32_swap_b32 v187, v195
    v_permlane32_swap_b32 v188, v196
    v_permlane32_swap_b32 v189, v197
    v_permlane32_swap_b32 v190, v198
    v_permlane32_swap_b32 v191, v199
    s_nop 0
    v_add_f32 v184, v184, v192
    v_add_f32 v185, v185, v193
    v_add_f32 v186, v186, v194
    v_add_f32 v187, v187, v195
    v_add_f32 v188, v188, v196
    v_add_f32 v189, v189, v197
    v_add_f32 v190, v190, v198
    v_add_f32 v191, v191, v199
    v_cndmask_b32 v184, v184, v186, s[50:51]
    v_cndmask_b32 v185, v185, v187, s[50:51]
    v_cndmask_b32 v184, v184, v188, s[52:53]
    v_cndmask_b32 v185, v185, v189, s[52:53]
    v_cndmask_b32 v184, v184, v190, s[54:55]
    v_cndmask_b32 v185, v185, v191, s[54:55]
kA_15:
    s_cmp_lt_u32 s33, 2
    s_cbranch_scc1 kA_17
    s_waitcnt vmcnt(0)
    v_mov_b32 v4, 0x3f803f80
    v_mov_b32 v168, 0
    v_mov_b32 v169, 0
    v_mov_b32 v170, 0
    v_mov_b32 v171, 0
    v_mov_b32 v172, 0
    v_mov_b32 v173, 0
    v_mov_b32 v174, 0
    v_mov_b32 v175, 0
    v_dot2_f32_bf16 v168, v152, v4, v168
    v_dot2_f32_bf16 v172, v152, v152, v172
    v_dot2_f32_bf16 v169, v156, v4, v169
    v_dot2_f32_bf16 v173, v156, v156, v173
    v_dot2_f32_bf16 v170, v160, v4, v170
    v_dot2_f32_bf16 v174, v160, v160, v174
    v_dot2_f32_bf16 v171, v164, v4, v171
    v_dot2_f32_bf16 v175, v164, v164, v175
    v_dot2_f32_bf16 v168, v153, v4, v168
    v_dot2_f32_bf16 v172, v153, v153, v172
    v_dot2_f32_bf16 v169, v157, v4, v169
    v_dot2_f32_bf16 v173, v157, v157, v173
    v_dot2_f32_bf16 v170, v161, v4, v170
    v_dot2_f32_bf16 v174, v161, v161, v174
    v_dot2_f32_bf16 v171, v165, v4, v171
    v_dot2_f32_bf16 v175, v165, v165, v175
    v_dot2_f32_bf16 v168, v154, v4, v168
    v_dot2_f32_bf16 v172, v154, v154, v172
    v_dot2_f32_bf16 v169, v158, v4, v169
    v_dot2_f32_bf16 v173, v158, v158, v173
    v_dot2_f32_bf16 v170, v162, v4, v170
    v_dot2_f32_bf16 v174, v162, v162, v174
    v_dot2_f32_bf16 v171, v166, v4, v171
    v_dot2_f32_bf16 v175, v166, v166, v175
    v_dot2_f32_bf16 v168, v155, v4, v168
    v_dot2_f32_bf16 v172, v155, v155, v172
    v_dot2_f32_bf16 v169, v159, v4, v169
    v_dot2_f32_bf16 v173, v159, v159, v173
    v_dot2_f32_bf16 v170, v163, v4, v170
    v_dot2_f32_bf16 v174, v163, v163, v174
    v_dot2_f32_bf16 v171, v167, v4, v171
    v_dot2_f32_bf16 v175, v167, v167, v175
    s_nop 2
    v_add_f32_dpp v168, v168, v168 row_shr:1 row_mask:0xf bank_mask:0xf
    v_add_f32_dpp v169, v169, v169 row_shr:1 row_mask:0xf bank_mask:0xf
    v_add_f32_dpp v170, v170, v170 row_shr:1 row_mask:0xf bank_mask:0xf
    v_add_f32_dpp v171, v171, v171 row_shr:1 row_mask:0xf bank_mask:0xf
    v_add_f32_dpp v172, v172, v172 row_shr:1 row_mask:0xf bank_mask:0xf
    v_add_f32_dpp v173, v173, v173 row_shr:1 row_mask:0xf bank_mask:0xf
    v_add_f32_dpp v174, v174, v174 row_shr:1 row_mask:0xf bank_mask:0xf
    v_add_f32_dpp v175, v175, v175 row_shr:1 row_mask:0xf bank_mask:0xf
    v_add_f32_dpp v168, v168, v168 row_shr:2 row_mask:0xf bank_mask:0xf
    v_add_f32_dpp v169, v169, v169 row_shr:2 row_mask:0xf bank_mask:0xf
    v_add_f32_dpp v170, v170, v170 row_shr:2 row_mask:0xf bank_mask:0xf
    v_add_f32_dpp v171, v171, v171 row_shr:2 row_mask:0xf bank_mask:0xf
    v_add_f32_dpp v172, v172, v172 row_shr:2 row_mask:0xf bank_mask:0xf
    v_add_f32_dpp v173, v173, v173 row_shr:2 row_mask:0xf bank_mask:0xf
    v_add_f32_dpp v174, v174, v174 row_shr:2 row_mask:0xf bank_mask:0xf
    v_add_f32_dpp v175, v175, v175 row_shr:2 row_mask:0xf bank_mask:0xf
    v_add_f32_dpp v168, v168, v168 row_shr:4 row_mask:0xf bank_mask:0xf
    v_add_f32_dpp v169, v169, v169 row_shr:4 row_mask:0xf bank_mask:0xf
    v_add_f32_dpp v170, v170, v170 row_shr:4 row_mask:0xf bank_mask:0xf
    v_add_f32_dpp v171, v171, v171 row_shr:4 row_mask:0xf bank_mask:0xf
    v_add_f32_dpp v172, v172, v172 row_shr:4 row_mask:0xf bank_mask:0xf
    v_add_f32_dpp v173, v173, v173 row_shr:4 row_mask:0xf bank_mask:0xf
    v_add_f32_dpp v174, v174, v174 row_shr:4 row_mask:0xf bank_mask:0xf
    v_add_f32_dpp v175, v175, v175 row_shr:4 row_mask:0xf bank_mask:0xf
    v_add_f32_dpp v168, v168, v168 row_shr:8 row_mask:0xf bank_mask:0xf
    v_add_f32_dpp v169, v169, v169 row_shr:8 row_mask:0xf bank_mask:0xf
    v_add_f32_dpp v170, v170, v170 row_shr:8 row_mask:0xf bank_mask:0xf
    v_add_f32_dpp v171, v171, v171 row_shr:8 row_mask:0xf bank_mask:0xf
    v_add_f32_dpp v172, v172, v172 row_shr:8 row_mask:0xf bank_mask:0xf
    v_add_f32_dpp v173, v173, v173 row_shr:8 row_mask:0xf bank_mask:0xf
    v_add_f32_dpp v174, v174, v174 row_shr:8 row_mask:0xf bank_mask:0xf
    v_add_f32_dpp v175, v175, v175 row_shr:8 row_mask:0xf bank_mask:0xf
    v_add_f32_dpp v168, v168, v168 row_bcast:15 row_mask:0xa bank_mask:0xf
    v_add_f32_dpp v169, v169, v169 row_bcast:15 row_mask:0xa bank_mask:0xf
    v_add_f32_dpp v170, v170, v170 row_bcast:15 row_mask:0xa bank_mask:0xf
    v_add_f32_dpp v171, v171, v171 row_bcast:15 row_mask:0xa bank_mask:0xf
    v_add_f32_dpp v172, v172, v172 row_bcast:15 row_mask:0xa bank_mask:0xf
    v_add_f32_dpp v173, v173, v173 row_bcast:15 row_mask:0xa bank_mask:0xf
    v_add_f32_dpp v174, v174, v174 row_bcast:15 row_mask:0xa bank_mask:0xf
    v_add_f32_dpp v175, v175, v175 row_bcast:15 row_mask:0xa bank_mask:0xf
    v_add_f32_dpp v168, v168, v168 row_bcast:31 row_mask:0xc bank_mask:0xf
    v_add_f32_dpp v169, v169, v169 row_bcast:31 row_mask:0xc bank_mask:0xf
    v_add_f32_dpp v170, v170, v170 row_bcast:31 row_mask:0xc bank_mask:0xf
    v_add_f32_dpp v171, v171, v171 row_bcast:31 row_mask:0xc bank_mask:0xf
    v_add_f32_dpp v172, v172, v172 row_bcast:31 row_mask:0xc bank_mask:0xf
    v_add_f32_dpp v173, v173, v173 row_bcast:31 row_mask:0xc bank_mask:0xf
    v_add_f32_dpp v174, v174, v174 row_bcast:31 row_mask:0xc bank_mask:0xf
    v_add_f32_dpp v175, v175, v175 row_bcast:31 row_mask:0xc bank_mask:0xf
    v_mov_b32 v5, 0x3727c5ac
    v_mul_f32 v176, 0x3b000000, v168
    v_mul_f32 v180, 0x3b000000, v169
    v_mul_f32 v184, 0x3b000000, v170
    v_mul_f32 v188, 0x3b000000, v171
    v_mul_f32 v192, 0x3b000000, v172
    v_mul_f32 v193, 0x3b000000, v173
    v_mul_f32 v194, 0x3b000000, v174
    v_mul_f32 v195, 0x3b000000, v175
    v_fma_f32 v192, -v176, v176, v192
    v_fma_f32 v193, -v180, v180, v193
    v_fma_f32 v194, -v184, v184, v194
    v_fma_f32 v195, -v188, v188, v195
    v_max_f32 v192, 0, v192
    v_max_f32 v193, 0, v193
    v_max_f32 v194, 0, v194
    v_max_f32 v195, 0, v195
    v_add_f32 v177, v5, v192
    v_add_f32 v181, v5, v193
    v_add_f32 v185, v5, v194
    v_add_f32 v189, v5, v195
    v_rsq_f32 v177, v177
    v_rsq_f32 v181, v181
    v_rsq_f32 v185, v185
    v_rsq_f32 v189, v189
    v_mul_f32 v178, v177, v177
    v_mul_f32 v182, v181, v181
    v_mul_f32 v186, v185, v185
    v_mul_f32 v190, v189, v189
    v_fma_f32 v178, v178, v192, v5
    v_fma_f32 v182, v182, v193, v5
    v_fma_f32 v186, v186, v194, v5
    v_fma_f32 v190, v190, v195, v5
    v_rsq_f32 v178, v178
    v_rsq_f32 v182, v182
    v_rsq_f32 v186, v186
    v_rsq_f32 v190, v190
    s_nop 0
    v_mul_f32 v178, v178, v177
    v_mul_f32 v182, v182, v181
    v_mul_f32 v186, v186, v185
    v_mul_f32 v190, v190, v189
kA_17:
    s_barrier
    ds_read_b64_tr_b16 v[24:25], v12 offset:0
    ds_read_b64_tr_b16 v[26:27], v12 offset:1024
    ds_read_b128 v[16:19], v8 offset:0
    ds_read_b128 v[20:23], v8 offset:4096
    ds_read_b64_tr_b16 v[28:29], v13 offset:0
    ds_read_b64_tr_b16 v[30:31], v13 offset:1024
    s_waitcnt lgkmcnt(0)
    v_mfma_f32_32x32x16_bf16 v[64:79], v[24:27], v[16:19], 0
    ds_read_b64_tr_b16 v[40:41], v12 offset:4096
    ds_read_b64_tr_b16 v[42:43], v12 offset:5120
    v_mfma_f32_32x32x16_bf16 v[96:111], v[24:27], v[20:23], 0
    ds_read_b128 v[32:35], v9 offset:0
    ds_read_b128 v[36:39], v9 offset:4096
    v_mfma_f32_32x32x16_bf16 v[80:95], v[28:31], v[16:19], 0
    ds_read_b64_tr_b16 v[44:45], v13 offset:4096
    ds_read_b64_tr_b16 v[46:47], v13 offset:5120
    v_mfma_f32_32x32x16_bf16 v[112:127], v[28:31], v[20:23], 0
    s_waitcnt lgkmcnt(0)
    v_mfma_f32_32x32x16_bf16 v[64:79], v[40:43], v[32:35], v[64:79]
    ds_read_b64_tr_b16 v[24:25], v12 offset:8192
    ds_read_b64_tr_b16 v[26:27], v12 offset:9216
    v_mfma_f32_32x32x16_bf16 v[96:111], v[40:43], v[36:39], v[96:111]
    ds_read_b128 v[16:19], v10 offset:0
    ds_read_b128 v[20:23], v10 offset:4096
    v_mfma_f32_32x32x16_bf16 v[80:95], v[44:47], v[32:35], v[80:95]
    ds_read_b64_tr_b16 v[28:29], v13 offset:8192
    ds_read_b64_tr_b16 v[30:31], v13 offset:9216
    v_mfma_f32_32x32x16_bf16 v[112:127], v[44:47], v[36:39], v[112:127]
    s_waitcnt lgkmcnt(0)
    v_mfma_f32_32x32x16_bf16 v[64:79], v[24:27], v[16:19], v[64:79]
    ds_read_b64_tr_b16 v[40:41], v12 offset:12288
    ds_read_b64_tr_b16 v[42:43], v12 offset:13312
    v_mfma_f32_32x32x16_bf16 v[96:111], v[24:27], v[20:23], v[96:111]
    ds_read_b128 v[32:35], v11 offset:0
    ds_read_b128 v[36:39], v11 offset:4096
    v_mfma_f32_32x32x16_bf16 v[80:95], v[28:31], v[16:19], v[80:95]
    ds_read_b64_tr_b16 v[44:45], v13 offset:12288
    ds_read_b64_tr_b16 v[46:47], v13 offset:13312
    v_mfma_f32_32x32x16_bf16 v[112:127], v[28:31], v[20:23], v[112:127]
    s_cmp_lg_u32 s33, 0
    s_cbranch_scc1 kA_18
    s_waitcnt vmcnt(0)
    s_mov_b32 s46, 0x20000
    s_add_u32 s47, s27, 16
kA_19:
    v_readlane_b32 s58, v49, s26
    v_readlane_b32 s59, v49, s47
    s_nop 3
    s_cmp_eq_u32 s58, 0
    s_cselect_b32 s50, 1, 0
    s_cmp_eq_u32 s59, 0
    s_cselect_b32 s50, 1, s50
    s_cmp_eq_u32 s50, 0
    s_cbranch_scc1 kA_20
    s_sub_u32 s46, s46, 1
    s_cmp_eq_u32 s46, 0
    s_cbranch_scc1 kA_20
    global_load_dword v49, v3, s[20:21] sc0 sc1
    s_waitcnt vmcnt(0)
    s_branch kA_19
kA_20:
    v_mov_b32 v4, s58
    v_mov_b32 v5, s59
    v_mov_b32 v6, 133632
    ds_write_b64 v6, v[4:5]
kA_18:
    s_waitcnt lgkmcnt(0)
    v_mfma_f32_32x32x16_bf16 v[64:79], v[40:43], v[32:35], v[64:79]
    s_barrier
    ds_read_b64_tr_b16 v[24:25], v12 offset:32768
    ds_read_b64_tr_b16 v[26:27], v12 offset:33792
    v_mfma_f32_32x32x16_bf16 v[96:111], v[40:43], v[36:39], v[96:111]
    ds_read_b128 v[16:19], v8 offset:32768
    ds_read_b128 v[20:23], v8 offset:36864
    v_mfma_f32_32x32x16_bf16 v[80:95], v[44:47], v[32:35], v[80:95]
    ds_read_b64_tr_b16 v[28:29], v13 offset:32768
    ds_read_b64_tr_b16 v[30:31], v13 offset:33792
    v_mfma_f32_32x32x16_bf16 v[112:127], v[44:47], v[36:39], v[112:127]
    s_waitcnt lgkmcnt(0)
    v_mfma_f32_32x32x16_bf16 v[64:79], v[24:27], v[16:19], v[64:79]
    ds_read_b64_tr_b16 v[40:41], v12 offset:36864
    ds_read_b64_tr_b16 v[42:43], v12 offset:37888
    v_mfma_f32_32x32x16_bf16 v[96:111], v[24:27], v[20:23], v[96:111]
    ds_read_b128 v[32:35], v9 offset:32768
    ds_read_b128 v[36:39], v9 offset:36864
    v_mfma_f32_32x32x16_bf16 v[80:95], v[28:31], v[16:19], v[80:95]
    ds_read_b64_tr_b16 v[44:45], v13 offset:36864
    ds_read_b64_tr_b16 v[46:47], v13 offset:37888
    v_mfma_f32_32x32x16_bf16 v[112:127], v[28:31], v[20:23], v[112:127]
    v_mov_b32 v52, 133632
    ds_read_b64 v[54:55], v52
    s_waitcnt lgkmcnt(0)
    v_readfirstlane_b32 s58, v54
    v_readfirstlane_b32 s59, v55
    s_cmp_ge_u32 s33, 2
    s_cbranch_scc1 kA_21
    v_mov_b32 v186, s59
    v_mov_b32 v187, s59
    s_lshl_b32 s47, s27, 4
    s_add_u32 s47, s47, s26
    s_lshl_b32 s47, s47, 10
    s_add_u32 s47, s47, 0x1600000
    s_lshl_b32 s46, s33, 9
    s_add_u32 s47, s47, s46
    v_and_b32 v6, 7, v2
    v_bfe_u32 v7, v2, 3, 2
    v_lshl_add_u32 v6, v6, 2, v7
    v_lshlrev_b32 v6, 4, v6
    s_mov_b32 exec_hi, 0
    buffer_store_dwordx4 v[184:187], v6, s[28:31], s47 offen sc0 sc1
    s_mov_b32 exec_hi, -1
kA_21:
    s_cmp_lt_u32 s33, 2
    s_cbranch_scc1 kA_22
    v_mov_b32 v179, s58
    v_mov_b32 v183, s58
    v_mov_b32 v187, s58
    v_mov_b32 v191, s58
    s_lshl_b32 s46, s61, 4
    s_add_u32 s46, s46, 0x1400000
    v_mov_b32 v6, 0
    s_mov_b64 s[48:49], exec
    s_mov_b32 exec_lo, 0
    s_mov_b32 exec_hi, 0x80000000
    buffer_store_dwordx4 v[176:179], v6, s[28:31], s46 offen offset:0 sc0 sc1
    buffer_store_dwordx4 v[180:183], v6, s[28:31], s46 offen offset:16 sc0 sc1
    buffer_store_dwordx4 v[184:187], v6, s[28:31], s46 offen offset:32 sc0 sc1
    buffer_store_dwordx4 v[188:191], v6, s[28:31], s46 offen offset:48 sc0 sc1
    s_mov_b64 exec, s[48:49]
kA_22:
    s_waitcnt lgkmcnt(0)
    v_mfma_f32_32x32x16_bf16 v[64:79], v[40:43], v[32:35], v[64:79]
    ds_read_b64_tr_b16 v[24:25], v12 offset:40960
    ds_read_b64_tr_b16 v[26:27], v12 offset:41984
    v_mfma_f32_32x32x16_bf16 v[96:111], v[40:43], v[36:39], v[96:111]
    ds_read_b128 v[16:19], v10 offset:32768
    ds_read_b128 v[20:23], v10 offset:36864
    v_mfma_f32_32x32x16_bf16 v[80:95], v[44:47], v[32:35], v[80:95]
    ds_read_b64_tr_b16 v[28:29], v13 offset:40960
    ds_read_b64_tr_b16 v[30:31], v13 offset:41984
    v_mfma_f32_32x32x16_bf16 v[112:127], v[44:47], v[36:39], v[112:127]
    s_waitcnt lgkmcnt(0)
    v_mfma_f32_32x32x16_bf16 v[64:79], v[24:27], v[16:19], v[64:79]
    ds_read_b64_tr_b16 v[40:41], v12 offset:45056
    ds_read_b64_tr_b16 v[42:43], v12 offset:46080
    v_mfma_f32_32x32x16_bf16 v[96:111], v[24:27], v[20:23], v[96:111]
    ds_read_b128 v[32:35], v11 offset:32768
    ds_read_b128 v[36:39], v11 offset:36864
    v_mfma_f32_32x32x16_bf16 v[80:95], v[28:31], v[16:19], v[80:95]
    ds_read_b64_tr_b16 v[44:45], v13 offset:45056
    ds_read_b64_tr_b16 v[46:47], v13 offset:46080
    v_mfma_f32_32x32x16_bf16 v[112:127], v[28:31], v[20:23], v[112:127]
    s_waitcnt lgkmcnt(0)
    v_mfma_f32_32x32x16_bf16 v[64:79], v[40:43], v[32:35], v[64:79]
    s_barrier
    v_add_u32 v8, 0x10000, v8
    v_add_u32 v9, 0x10000, v9
    v_add_u32 v10, 0x10000, v10
    v_add_u32 v11, 0x10000, v11
    v_add_u32 v12, 0x10000, v12
    v_add_u32 v13, 0x10000, v13
    ds_read_b64_tr_b16 v[24:25], v12 offset:0
    ds_read_b64_tr_b16 v[26:27], v12 offset:1024
    v_mfma_f32_32x32x16_bf16 v[96:111], v[40:43], v[36:39], v[96:111]
    ds_read_b128 v[16:19], v8 offset:0
    ds_read_b128 v[20:23], v8 offset:4096
    v_mfma_f32_32x32x16_bf16 v[80:95], v[44:47], v[32:35], v[80:95]
    ds_read_b64_tr_b16 v[28:29], v13 offset:0
    ds_read_b64_tr_b16 v[30:31], v13 offset:1024
    v_mfma_f32_32x32x16_bf16 v[112:127], v[44:47], v[36:39], v[112:127]
    s_waitcnt lgkmcnt(0)
    v_mfma_f32_32x32x16_bf16 v[64:79], v[24:27], v[16:19], v[64:79]
    ds_read_b64_tr_b16 v[40:41], v12 offset:4096
    ds_read_b64_tr_b16 v[42:43], v12 offset:5120
    v_mfma_f32_32x32x16_bf16 v[96:111], v[24:27], v[20:23], v[96:111]
    ds_read_b128 v[32:35], v9 offset:0
    ds_read_b128 v[36:39], v9 offset:4096
    v_mfma_f32_32x32x16_bf16 v[80:95], v[28:31], v[16:19], v[80:95]
    ds_read_b64_tr_b16 v[44:45], v13 offset:4096
    ds_read_b64_tr_b16 v[46:47], v13 offset:5120
    v_mfma_f32_32x32x16_bf16 v[112:127], v[28:31], v[20:23], v[112:127]
    s_waitcnt lgkmcnt(0)
    v_mfma_f32_32x32x16_bf16 v[64:79], v[40:43], v[32:35], v[64:79]
    ds_read_b64_tr_b16 v[24:25], v12 offset:8192
    ds_read_b64_tr_b16 v[26:27], v12 offset:9216
    v_mfma_f32_32x32x16_bf16 v[96:111], v[40:43], v[36:39], v[96:111]
    ds_read_b128 v[16:19], v10 offset:0
    ds_read_b128 v[20:23], v10 offset:4096
    v_mfma_f32_32x32x16_bf16 v[80:95], v[44:47], v[32:35], v[80:95]
    ds_read_b64_tr_b16 v[28:29], v13 offset:8192
    ds_read_b64_tr_b16 v[30:31], v13 offset:9216
    v_mfma_f32_32x32x16_bf16 v[112:127], v[44:47], v[36:39], v[112:127]
    s_waitcnt lgkmcnt(0)
    v_mfma_f32_32x32x16_bf16 v[64:79], v[24:27], v[16:19], v[64:79]
    ds_read_b64_tr_b16 v[40:41], v12 offset:12288
    ds_read_b64_tr_b16 v[42:43], v12 offset:13312
    v_mfma_f32_32x32x16_bf16 v[96:111], v[24:27], v[20:23], v[96:111]
    ds_read_b128 v[32:35], v11 offset:0
    ds_read_b128 v[36:39], v11 offset:4096
    v_mfma_f32_32x32x16_bf16 v[80:95], v[28:31], v[16:19], v[80:95]
    ds_read_b64_tr_b16 v[44:45], v13 offset:12288
    ds_read_b64_tr_b16 v[46:47], v13 offset:13312
    v_mfma_f32_32x32x16_bf16 v[112:127], v[28:31], v[20:23], v[112:127]
    s_waitcnt lgkmcnt(0)
    v_mfma_f32_32x32x16_bf16 v[64:79], v[40:43], v[32:35], v[64:79]
    s_barrier
    ds_read_b64_tr_b16 v[24:25], v12 offset:32768
    ds_read_b64_tr_b16 v[26:27], v12 offset:33792
    v_mfma_f32_32x32x16_bf16 v[96:111], v[40:43], v[36:39], v[96:111]
    ds_read_b128 v[16:19], v8 offset:32768
    ds_read_b128 v[20:23], v8 offset:36864
    v_mfma_f32_32x32x16_bf16 v[80:95], v[44:47], v[32:35], v[80:95]
    ds_read_b64_tr_b16 v[28:29], v13 offset:32768
    ds_read_b64_tr_b16 v[30:31], v13 offset:33792
    v_mfma_f32_32x32x16_bf16 v[112:127], v[44:47], v[36:39], v[112:127]
    s_waitcnt lgkmcnt(0)
    v_mfma_f32_32x32x16_bf16 v[64:79], v[24:27], v[16:19], v[64:79]
    ds_read_b64_tr_b16 v[40:41], v12 offset:36864
    ds_read_b64_tr_b16 v[42:43], v12 offset:37888
    v_mfma_f32_32x32x16_bf16 v[96:111], v[24:27], v[20:23], v[96:111]
    ds_read_b128 v[32:35], v9 offset:32768
    ds_read_b128 v[36:39], v9 offset:36864
    v_mfma_f32_32x32x16_bf16 v[80:95], v[28:31], v[16:19], v[80:95]
    ds_read_b64_tr_b16 v[44:45], v13 offset:36864
    ds_read_b64_tr_b16 v[46:47], v13 offset:37888
    v_mfma_f32_32x32x16_bf16 v[112:127], v[28:31], v[20:23], v[112:127]
    s_waitcnt lgkmcnt(0)
    v_mfma_f32_32x32x16_bf16 v[64:79], v[40:43], v[32:35], v[64:79]
    ds_read_b64_tr_b16 v[24:25], v12 offset:40960
    ds_read_b64_tr_b16 v[26:27], v12 offset:41984
    v_mfma_f32_32x32x16_bf16 v[96:111], v[40:43], v[36:39], v[96:111]
    ds_read_b128 v[16:19], v10 offset:32768
    ds_read_b128 v[20:23], v10 offset:36864
    v_mfma_f32_32x32x16_bf16 v[80:95], v[44:47], v[32:35], v[80:95]
    ds_read_b64_tr_b16 v[28:29], v13 offset:40960
    ds_read_b64_tr_b16 v[30:31], v13 offset:41984
    v_mfma_f32_32x32x16_bf16 v[112:127], v[44:47], v[36:39], v[112:127]
    s_waitcnt lgkmcnt(0)
    v_mfma_f32_32x32x16_bf16 v[64:79], v[24:27], v[16:19], v[64:79]
    ds_read_b64_tr_b16 v[40:41], v12 offset:45056
    ds_read_b64_tr_b16 v[42:43], v12 offset:46080
    v_mfma_f32_32x32x16_bf16 v[96:111], v[24:27], v[20:23], v[96:111]
    ds_read_b128 v[32:35], v11 offset:32768
    ds_read_b128 v[36:39], v11 offset:36864
    v_mfma_f32_32x32x16_bf16 v[80:95], v[28:31], v[16:19], v[80:95]
    ds_read_b64_tr_b16 v[44:45], v13 offset:45056
    ds_read_b64_tr_b16 v[46:47], v13 offset:46080
    v_mfma_f32_32x32x16_bf16 v[112:127], v[28:31], v[20:23], v[112:127]
    s_waitcnt lgkmcnt(0)
    v_mfma_f32_32x32x16_bf16 v[64:79], v[40:43], v[32:35], v[64:79]
    s_barrier
    v_add_u32 v8, 0xffff0000, v8
    v_add_u32 v9, 0xffff0000, v9
    v_add_u32 v10, 0xffff0000, v10
    v_add_u32 v11, 0xffff0000, v11
    v_add_u32 v12, 0xffff0000, v12
    v_add_u32 v13, 0xffff0000, v13
    ds_read_b64_tr_b16 v[24:25], v12 offset:0
    ds_read_b64_tr_b16 v[26:27], v12 offset:1024
    v_mfma_f32_32x32x16_bf16 v[96:111], v[40:43], v[36:39], v[96:111]
    ds_read_b128 v[16:19], v8 offset:0
    ds_read_b128 v[20:23], v8 offset:4096
    v_mfma_f32_32x32x16_bf16 v[80:95], v[44:47], v[32:35], v[80:95]
    ds_read_b64_tr_b16 v[28:29], v13 offset:0
    ds_read_b64_tr_b16 v[30:31], v13 offset:1024
    v_mfma_f32_32x32x16_bf16 v[112:127], v[44:47], v[36:39], v[112:127]
    s_waitcnt lgkmcnt(0)
    v_mfma_f32_32x32x16_bf16 v[64:79], v[24:27], v[16:19], v[64:79]
    ds_read_b64_tr_b16 v[40:41], v12 offset:4096
    ds_read_b64_tr_b16 v[42:43], v12 offset:5120
    v_mfma_f32_32x32x16_bf16 v[96:111], v[24:27], v[20:23], v[96:111]
    ds_read_b128 v[32:35], v9 offset:0
    ds_read_b128 v[36:39], v9 offset:4096
    v_mfma_f32_32x32x16_bf16 v[80:95], v[28:31], v[16:19], v[80:95]
    ds_read_b64_tr_b16 v[44:45], v13 offset:4096
    ds_read_b64_tr_b16 v[46:47], v13 offset:5120
    v_mfma_f32_32x32x16_bf16 v[112:127], v[28:31], v[20:23], v[112:127]
    s_waitcnt lgkmcnt(0)
    v_mfma_f32_32x32x16_bf16 v[64:79], v[40:43], v[32:35], v[64:79]
    ds_read_b64_tr_b16 v[24:25], v12 offset:8192
    ds_read_b64_tr_b16 v[26:27], v12 offset:9216
    v_mfma_f32_32x32x16_bf16 v[96:111], v[40:43], v[36:39], v[96:111]
    ds_read_b128 v[16:19], v10 offset:0
    ds_read_b128 v[20:23], v10 offset:4096
    v_mfma_f32_32x32x16_bf16 v[80:95], v[44:47], v[32:35], v[80:95]
    ds_read_b64_tr_b16 v[28:29], v13 offset:8192
    ds_read_b64_tr_b16 v[30:31], v13 offset:9216
    v_mfma_f32_32x32x16_bf16 v[112:127], v[44:47], v[36:39], v[112:127]
    s_waitcnt lgkmcnt(0)
    v_mfma_f32_32x32x16_bf16 v[64:79], v[24:27], v[16:19], v[64:79]
    ds_read_b64_tr_b16 v[40:41], v12 offset:12288
    ds_read_b64_tr_b16 v[42:43], v12 offset:13312
    v_mfma_f32_32x32x16_bf16 v[96:111], v[24:27], v[20:23], v[96:111]
    ds_read_b128 v[32:35], v11 offset:0
    ds_read_b128 v[36:39], v11 offset:4096
    v_mfma_f32_32x32x16_bf16 v[80:95], v[28:31], v[16:19], v[80:95]
    ds_read_b64_tr_b16 v[44:45], v13 offset:12288
    ds_read_b64_tr_b16 v[46:47], v13 offset:13312
    v_mfma_f32_32x32x16_bf16 v[112:127], v[28:31], v[20:23], v[112:127]
    s_waitcnt lgkmcnt(0)
    v_mfma_f32_32x32x16_bf16 v[64:79], v[40:43], v[32:35], v[64:79]
    s_barrier
    ds_read_b64_tr_b16 v[24:25], v12 offset:32768
    ds_read_b64_tr_b16 v[26:27], v12 offset:33792
    v_mfma_f32_32x32x16_bf16 v[96:111], v[40:43], v[36:39], v[96:111]
    ds_read_b128 v[16:19], v8 offset:32768
    ds_read_b128 v[20:23], v8 offset:36864
    v_mfma_f32_32x32x16_bf16 v[80:95], v[44:47], v[32:35], v[80:95]
    ds_read_b64_tr_b16 v[28:29], v13 offset:32768
    ds_read_b64_tr_b16 v[30:31], v13 offset:33792
    v_mfma_f32_32x32x16_bf16 v[112:127], v[44:47], v[36:39], v[112:127]
    s_waitcnt lgkmcnt(0)
    v_mfma_f32_32x32x16_bf16 v[64:79], v[24:27], v[16:19], v[64:79]
    ds_read_b64_tr_b16 v[40:41], v12 offset:36864
    ds_read_b64_tr_b16 v[42:43], v12 offset:37888
    v_mfma_f32_32x32x16_bf16 v[96:111], v[24:27], v[20:23], v[96:111]
    ds_read_b128 v[32:35], v9 offset:32768
    ds_read_b128 v[36:39], v9 offset:36864
    v_mfma_f32_32x32x16_bf16 v[80:95], v[28:31], v[16:19], v[80:95]
    ds_read_b64_tr_b16 v[44:45], v13 offset:36864
    ds_read_b64_tr_b16 v[46:47], v13 offset:37888
    v_mfma_f32_32x32x16_bf16 v[112:127], v[28:31], v[20:23], v[112:127]
    s_waitcnt lgkmcnt(0)
    v_mfma_f32_32x32x16_bf16 v[64:79], v[40:43], v[32:35], v[64:79]
    ds_read_b64_tr_b16 v[24:25], v12 offset:40960
    ds_read_b64_tr_b16 v[26:27], v12 offset:41984
    v_mfma_f32_32x32x16_bf16 v[96:111], v[40:43], v[36:39], v[96:111]
    ds_read_b128 v[16:19], v10 offset:32768
    ds_read_b128 v[20:23], v10 offset:36864
    v_mfma_f32_32x32x16_bf16 v[80:95], v[44:47], v[32:35], v[80:95]
    ds_read_b64_tr_b16 v[28:29], v13 offset:40960
    ds_read_b64_tr_b16 v[30:31], v13 offset:41984
    v_mfma_f32_32x32x16_bf16 v[112:127], v[44:47], v[36:39], v[112:127]
    s_waitcnt lgkmcnt(0)
    v_mfma_f32_32x32x16_bf16 v[64:79], v[24:27], v[16:19], v[64:79]
    ds_read_b64_tr_b16 v[40:41], v12 offset:45056
    ds_read_b64_tr_b16 v[42:43], v12 offset:46080
    v_mfma_f32_32x32x16_bf16 v[96:111], v[24:27], v[20:23], v[96:111]
    ds_read_b128 v[32:35], v11 offset:32768
    ds_read_b128 v[36:39], v11 offset:36864
    v_mfma_f32_32x32x16_bf16 v[80:95], v[28:31], v[16:19], v[80:95]
    ds_read_b64_tr_b16 v[44:45], v13 offset:45056
    ds_read_b64_tr_b16 v[46:47], v13 offset:46080
    v_mfma_f32_32x32x16_bf16 v[112:127], v[28:31], v[20:23], v[112:127]
    s_waitcnt lgkmcnt(0)
    v_mfma_f32_32x32x16_bf16 v[64:79], v[40:43], v[32:35], v[64:79]
    s_barrier
    v_add_u32 v8, 0x10000, v8
    v_add_u32 v9, 0x10000, v9
    v_add_u32 v10, 0x10000, v10
    v_add_u32 v11, 0x10000, v11
    v_add_u32 v12, 0x10000, v12
    v_add_u32 v13, 0x10000, v13
    ds_read_b64_tr_b16 v[24:25], v12 offset:0
    ds_read_b64_tr_b16 v[26:27], v12 offset:1024
    v_mfma_f32_32x32x16_bf16 v[96:111], v[40:43], v[36:39], v[96:111]
    ds_read_b128 v[16:19], v8 offset:0
    ds_read_b128 v[20:23], v8 offset:4096
    v_mfma_f32_32x32x16_bf16 v[80:95], v[44:47], v[32:35], v[80:95]
    ds_read_b64_tr_b16 v[28:29], v13 offset:0
    ds_read_b64_tr_b16 v[30:31], v13 offset:1024
    v_mfma_f32_32x32x16_bf16 v[112:127], v[44:47], v[36:39], v[112:127]
    s_waitcnt lgkmcnt(0)
    v_mfma_f32_32x32x16_bf16 v[64:79], v[24:27], v[16:19], v[64:79]
    ds_read_b64_tr_b16 v[40:41], v12 offset:4096
    ds_read_b64_tr_b16 v[42:43], v12 offset:5120
    v_mfma_f32_32x32x16_bf16 v[96:111], v[24:27], v[20:23], v[96:111]
    ds_read_b128 v[32:35], v9 offset:0
    ds_read_b128 v[36:39], v9 offset:4096
    v_mfma_f32_32x32x16_bf16 v[80:95], v[28:31], v[16:19], v[80:95]
    ds_read_b64_tr_b16 v[44:45], v13 offset:4096
    ds_read_b64_tr_b16 v[46:47], v13 offset:5120
    v_mfma_f32_32x32x16_bf16 v[112:127], v[28:31], v[20:23], v[112:127]
    s_waitcnt lgkmcnt(0)
    v_mfma_f32_32x32x16_bf16 v[64:79], v[40:43], v[32:35], v[64:79]
    ds_read_b64_tr_b16 v[24:25], v12 offset:8192
    ds_read_b64_tr_b16 v[26:27], v12 offset:9216
    v_mfma_f32_32x32x16_bf16 v[96:111], v[40:43], v[36:39], v[96:111]
    ds_read_b128 v[16:19], v10 offset:0
    ds_read_b128 v[20:23], v10 offset:4096
    v_mfma_f32_32x32x16_bf16 v[80:95], v[44:47], v[32:35], v[80:95]
    ds_read_b64_tr_b16 v[28:29], v13 offset:8192
    ds_read_b64_tr_b16 v[30:31], v13 offset:9216
    v_mfma_f32_32x32x16_bf16 v[112:127], v[44:47], v[36:39], v[112:127]
    s_waitcnt lgkmcnt(0)
    v_mfma_f32_32x32x16_bf16 v[64:79], v[24:27], v[16:19], v[64:79]
    ds_read_b64_tr_b16 v[40:41], v12 offset:12288
    ds_read_b64_tr_b16 v[42:43], v12 offset:13312
    v_mfma_f32_32x32x16_bf16 v[96:111], v[24:27], v[20:23], v[96:111]
    ds_read_b128 v[32:35], v11 offset:0
    ds_read_b128 v[36:39], v11 offset:4096
    v_mfma_f32_32x32x16_bf16 v[80:95], v[28:31], v[16:19], v[80:95]
    ds_read_b64_tr_b16 v[44:45], v13 offset:12288
    ds_read_b64_tr_b16 v[46:47], v13 offset:13312
    v_mfma_f32_32x32x16_bf16 v[112:127], v[28:31], v[20:23], v[112:127]
    s_waitcnt lgkmcnt(0)
    v_mfma_f32_32x32x16_bf16 v[64:79], v[40:43], v[32:35], v[64:79]
    s_barrier
    ds_read_b64_tr_b16 v[24:25], v12 offset:32768
    ds_read_b64_tr_b16 v[26:27], v12 offset:33792
    v_mfma_f32_32x32x16_bf16 v[96:111], v[40:43], v[36:39], v[96:111]
    ds_read_b128 v[16:19], v8 offset:32768
    ds_read_b128 v[20:23], v8 offset:36864
    v_mfma_f32_32x32x16_bf16 v[80:95], v[44:47], v[32:35], v[80:95]
    ds_read_b64_tr_b16 v[28:29], v13 offset:32768
    ds_read_b64_tr_b16 v[30:31], v13 offset:33792
    v_mfma_f32_32x32x16_bf16 v[112:127], v[44:47], v[36:39], v[112:127]
    s_waitcnt lgkmcnt(0)
    v_mfma_f32_32x32x16_bf16 v[64:79], v[24:27], v[16:19], v[64:79]
    ds_read_b64_tr_b16 v[40:41], v12 offset:36864
    ds_read_b64_tr_b16 v[42:43], v12 offset:37888
    v_mfma_f32_32x32x16_bf16 v[96:111], v[24:27], v[20:23], v[96:111]
    ds_read_b128 v[32:35], v9 offset:32768
    ds_read_b128 v[36:39], v9 offset:36864
    v_mfma_f32_32x32x16_bf16 v[80:95], v[28:31], v[16:19], v[80:95]
    ds_read_b64_tr_b16 v[44:45], v13 offset:36864
    ds_read_b64_tr_b16 v[46:47], v13 offset:37888
    v_mfma_f32_32x32x16_bf16 v[112:127], v[28:31], v[20:23], v[112:127]
    s_waitcnt lgkmcnt(0)
    v_mfma_f32_32x32x16_bf16 v[64:79], v[40:43], v[32:35], v[64:79]
    ds_read_b64_tr_b16 v[24:25], v12 offset:40960
    ds_read_b64_tr_b16 v[26:27], v12 offset:41984
    v_mfma_f32_32x32x16_bf16 v[96:111], v[40:43], v[36:39], v[96:111]
    ds_read_b128 v[16:19], v10 offset:32768
    ds_read_b128 v[20:23], v10 offset:36864
    v_mfma_f32_32x32x16_bf16 v[80:95], v[44:47], v[32:35], v[80:95]
    ds_read_b64_tr_b16 v[28:29], v13 offset:40960
    ds_read_b64_tr_b16 v[30:31], v13 offset:41984
    v_mfma_f32_32x32x16_bf16 v[112:127], v[44:47], v[36:39], v[112:127]
    s_waitcnt lgkmcnt(0)
    v_mfma_f32_32x32x16_bf16 v[64:79], v[24:27], v[16:19], v[64:79]
    ds_read_b64_tr_b16 v[40:41], v12 offset:45056
    ds_read_b64_tr_b16 v[42:43], v12 offset:46080
    v_mfma_f32_32x32x16_bf16 v[96:111], v[24:27], v[20:23], v[96:111]
    ds_read_b128 v[32:35], v11 offset:32768
    ds_read_b128 v[36:39], v11 offset:36864
    v_mfma_f32_32x32x16_bf16 v[80:95], v[28:31], v[16:19], v[80:95]
    ds_read_b64_tr_b16 v[44:45], v13 offset:45056
    ds_read_b64_tr_b16 v[46:47], v13 offset:46080
    v_mfma_f32_32x32x16_bf16 v[112:127], v[28:31], v[20:23], v[112:127]
    s_waitcnt lgkmcnt(0)
    v_mfma_f32_32x32x16_bf16 v[64:79], v[40:43], v[32:35], v[64:79]
    s_barrier
    v_mfma_f32_32x32x16_bf16 v[96:111], v[40:43], v[36:39], v[96:111]
    v_mfma_f32_32x32x16_bf16 v[80:95], v[44:47], v[32:35], v[80:95]
    v_mfma_f32_32x32x16_bf16 v[112:127], v[44:47], v[36:39], v[112:127]
    v_and_b32 v50, 31, v2
    v_lshlrev_b32 v50, 4, v50
    s_lshl_b32 s46, s38, 10
    s_add_u32 s46, s46, 131072
    v_add_u32 v50, s46, v50
    ds_read_b128 v[128:131], v50
    ds_read_b128 v[132:135], v50 offset:512
    v_lshrrev_b32 v51, 5, v2
    v_lshlrev_b32 v51, 4, v51
    s_lshl_b32 s46, s39, 8
    s_add_u32 s46, s46, 133120
    v_add_u32 v51, s46, v51
    ds_read_b128 v[16:19], v51 offset:0
    ds_read_b128 v[20:23], v51 offset:32
    ds_read_b128 v[24:27], v51 offset:64
    ds_read_b128 v[28:31], v51 offset:96
    ds_read_b128 v[32:35], v51 offset:128
    ds_read_b128 v[36:39], v51 offset:160
    ds_read_b128 v[40:43], v51 offset:192
    ds_read_b128 v[44:47], v51 offset:224
    s_waitcnt lgkmcnt(8)
    s_lshr_b32 s50, s27, 2
    s_and_b32 s51, s27, 3
    s_mov_b32 s52, 0x3f800000
    s_cmp_eq_u32 s50, 0
    s_cselect_b32 s52, 0x3eb8aa3b, s52
    s_cmp_eq_u32 s50, 3
    s_cbranch_scc1 kA_epi_h
    v_mul_f32 v52, s52, v129
    v_mul_f32 v54, s52, v133
    v_mul_f32_e64 v53, -v128, v52
    v_mul_f32_e64 v55, -v132, v54
    s_waitcnt lgkmcnt(0)
    v_pk_mul_f32 v[56:57], v[16:17], v[52:53] op_sel:[0,1] op_sel_hi:[1,1]
    v_pk_mul_f32 v[58:59], v[18:19], v[52:53] op_sel:[0,1] op_sel_hi:[1,1]
    v_pk_mul_f32 v[60:61], v[20:21], v[52:53] op_sel:[0,1] op_sel_hi:[1,1]
    v_pk_mul_f32 v[62:63], v[22:23], v[52:53] op_sel:[0,1] op_sel_hi:[1,1]
    v_pk_fma_f32 v[64:65], v[64:65], v[52:53], v[56:57] op_sel_hi:[1,0,1]
    v_pk_mul_f32 v[56:57], v[24:25], v[52:53] op_sel:[0,1] op_sel_hi:[1,1]
    v_pk_fma_f32 v[66:67], v[66:67], v[52:53], v[58:59] op_sel_hi:[1,0,1]
    v_pk_mul_f32 v[58:59], v[26:27], v[52:53] op_sel:[0,1] op_sel_hi:[1,1]
    v_pk_fma_f32 v[68:69], v[68:69], v[52:53], v[60:61] op_sel_hi:[1,0,1]
    v_pk_mul_f32 v[60:61], v[28:29], v[52:53] op_sel:[0,1] op_sel_hi:[1,1]
    v_pk_fma_f32 v[70:71], v[70:71], v[52:53], v[62:63] op_sel_hi:[1,0,1]
    v_pk_mul_f32 v[62:63], v[30:31], v[52:53] op_sel:[0,1] op_sel_hi:[1,1]
    v_pk_fma_f32 v[72:73], v[72:73], v[52:53], v[56:57] op_sel_hi:[1,0,1]
    v_pk_fma_f32 v[74:75], v[74:75], v[52:53], v[58:59] op_sel_hi:[1,0,1]
    v_pk_fma_f32 v[76:77], v[76:77], v[52:53], v[60:61] op_sel_hi:[1,0,1]
    v_pk_fma_f32 v[78:79], v[78:79], v[52:53], v[62:63] op_sel_hi:[1,0,1]
    v_pk_mul_f32 v[56:57], v[32:33], v[52:53] op_sel:[0,1] op_sel_hi:[1,1]
    v_pk_mul_f32 v[58:59], v[34:35], v[52:53] op_sel:[0,1] op_sel_hi:[1,1]
    v_pk_mul_f32 v[60:61], v[36:37], v[52:53] op_sel:[0,1] op_sel_hi:[1,1]
    v_pk_mul_f32 v[62:63], v[38:39], v[52:53] op_sel:[0,1] op_sel_hi:[1,1]
    v_pk_fma_f32 v[80:81], v[80:81], v[52:53], v[56:57] op_sel_hi:[1,0,1]
    v_pk_mul_f32 v[56:57], v[40:41], v[52:53] op_sel:[0,1] op_sel_hi:[1,1]
    v_pk_fma_f32 v[82:83], v[82:83], v[52:53], v[58:59] op_sel_hi:[1,0,1]
    v_pk_mul_f32 v[58:59], v[42:43], v[52:53] op_sel:[0,1] op_sel_hi:[1,1]
    v_pk_fma_f32 v[84:85], v[84:85], v[52:53], v[60:61] op_sel_hi:[1,0,1]
    v_pk_mul_f32 v[60:61], v[44:45], v[52:53] op_sel:[0,1] op_sel_hi:[1,1]
    v_pk_fma_f32 v[86:87], v[86:87], v[52:53], v[62:63] op_sel_hi:[1,0,1]
    v_pk_mul_f32 v[62:63], v[46:47], v[52:53] op_sel:[0,1] op_sel_hi:[1,1]
    v_pk_fma_f32 v[88:89], v[88:89], v[52:53], v[56:57] op_sel_hi:[1,0,1]
    v_pk_fma_f32 v[90:91], v[90:91], v[52:53], v[58:59] op_sel_hi:[1,0,1]
    v_pk_fma_f32 v[92:93], v[92:93], v[52:53], v[60:61] op_sel_hi:[1,0,1]
    v_pk_fma_f32 v[94:95], v[94:95], v[52:53], v[62:63] op_sel_hi:[1,0,1]
    v_pk_mul_f32 v[56:57], v[16:17], v[54:55] op_sel:[0,1] op_sel_hi:[1,1]
    v_pk_mul_f32 v[58:59], v[18:19], v[54:55] op_sel:[0,1] op_sel_hi:[1,1]
    v_pk_mul_f32 v[60:61], v[20:21], v[54:55] op_sel:[0,1] op_sel_hi:[1,1]
    v_pk_mul_f32 v[62:63], v[22:23], v[54:55] op_sel:[0,1] op_sel_hi:[1,1]
    v_pk_fma_f32 v[96:97], v[96:97], v[54:55], v[56:57] op_sel_hi:[1,0,1]
    v_pk_mul_f32 v[56:57], v[24:25], v[54:55] op_sel:[0,1] op_sel_hi:[1,1]
    v_pk_fma_f32 v[98:99], v[98:99], v[54:55], v[58:59] op_sel_hi:[1,0,1]
    v_pk_mul_f32 v[58:59], v[26:27], v[54:55] op_sel:[0,1] op_sel_hi:[1,1]
    v_pk_fma_f32 v[100:101], v[100:101], v[54:55], v[60:61] op_sel_hi:[1,0,1]
    v_pk_mul_f32 v[60:61], v[28:29], v[54:55] op_sel:[0,1] op_sel_hi:[1,1]
    v_pk_fma_f32 v[102:103], v[102:103], v[54:55], v[62:63] op_sel_hi:[1,0,1]
    v_pk_mul_f32 v[62:63], v[30:31], v[54:55] op_sel:[0,1] op_sel_hi:[1,1]
    v_pk_fma_f32 v[104:105], v[104:105], v[54:55], v[56:57] op_sel_hi:[1,0,1]
    v_pk_fma_f32 v[106:107], v[106:107], v[54:55], v[58:59] op_sel_hi:[1,0,1]
    v_pk_fma_f32 v[108:109], v[108:109], v[54:55], v[60:61] op_sel_hi:[1,0,1]
    v_pk_fma_f32 v[110:111], v[110:111], v[54:55], v[62:63] op_sel_hi:[1,0,1]
    v_pk_mul_f32 v[56:57], v[32:33], v[54:55] op_sel:[0,1] op_sel_hi:[1,1]
    v_pk_mul_f32 v[58:59], v[34:35], v[54:55] op_sel:[0,1] op_sel_hi:[1,1]
    v_pk_mul_f32 v[60:61], v[36:37], v[54:55] op_sel:[0,1] op_sel_hi:[1,1]
    v_pk_mul_f32 v[62:63], v[38:39], v[54:55] op_sel:[0,1] op_sel_hi:[1,1]
    v_pk_fma_f32 v[112:113], v[112:113], v[54:55], v[56:57] op_sel_hi:[1,0,1]
    v_pk_mul_f32 v[56:57], v[40:41], v[54:55] op_sel:[0,1] op_sel_hi:[1,1]
    v_pk_fma_f32 v[114:115], v[114:115], v[54:55], v[58:59] op_sel_hi:[1,0,1]
    v_pk_mul_f32 v[58:59], v[42:43], v[54:55] op_sel:[0,1] op_sel_hi:[1,1]
    v_pk_fma_f32 v[116:117], v[116:117], v[54:55], v[60:61] op_sel_hi:[1,0,1]
    v_pk_mul_f32 v[60:61], v[44:45], v[54:55] op_sel:[0,1] op_sel_hi:[1,1]
    v_pk_fma_f32 v[118:119], v[118:119], v[54:55], v[62:63] op_sel_hi:[1,0,1]
    v_pk_mul_f32 v[62:63], v[46:47], v[54:55] op_sel:[0,1] op_sel_hi:[1,1]
    v_pk_fma_f32 v[120:121], v[120:121], v[54:55], v[56:57] op_sel_hi:[1,0,1]
    v_pk_fma_f32 v[122:123], v[122:123], v[54:55], v[58:59] op_sel_hi:[1,0,1]
    v_pk_fma_f32 v[124:125], v[124:125], v[54:55], v[60:61] op_sel_hi:[1,0,1]
    v_pk_fma_f32 v[126:127], v[126:127], v[54:55], v[62:63] op_sel_hi:[1,0,1]
    v_lshlrev_b32 v50, 4, v2
    s_cmp_lg_u32 s50, 2
    s_cbranch_scc1 kA_23
    v_bfe_u32 v4, v2, 2, 3
    v_lshlrev_b32 v4, 3, v4
    v_lshrrev_b32 v5, 5, v2
    v_lshl_add_u32 v4, v5, 2, v4
    v_and_b32 v5, 3, v2
    v_add_u32 v4, v4, v5
    v_lshlrev_b32 v50, 4, v4
kA_23:
    s_lshl_b32 s46, s50, 21
    s_lshl_b32 s47, s51, 3
    s_lshl_b32 s53, s39, 2
    s_add_u32 s47, s47, s53
    s_lshl_b32 s47, s47, 16
    s_add_u32 s46, s46, s47
    s_lshl_b32 s47, s26, 2
    s_lshl_b32 s53, s38, 1
    s_add_u32 s47, s47, s53
    s_lshl_b32 s47, s47, 10
    s_add_u32 s46, s46, s47
    v_cvt_pk_bf16_f32 v136, v64, v65
    v_cvt_pk_bf16_f32 v137, v66, v67
    v_cvt_pk_bf16_f32 v138, v68, v69
    v_cvt_pk_bf16_f32 v139, v70, v71
    s_add_u32 s47, s46, 0
    buffer_store_dwordx4 v[136:139], v50, s[28:31], s47 offen
    v_cvt_pk_bf16_f32 v140, v72, v73
    v_cvt_pk_bf16_f32 v141, v74, v75
    v_cvt_pk_bf16_f32 v142, v76, v77
    v_cvt_pk_bf16_f32 v143, v78, v79
    s_add_u32 s47, s46, 65536
    buffer_store_dwordx4 v[140:143], v50, s[28:31], s47 offen
    v_cvt_pk_bf16_f32 v144, v80, v81
    v_cvt_pk_bf16_f32 v145, v82, v83
    v_cvt_pk_bf16_f32 v146, v84, v85
    v_cvt_pk_bf16_f32 v147, v86, v87
    s_add_u32 s47, s46, 131072
    buffer_store_dwordx4 v[144:147], v50, s[28:31], s47 offen
    v_cvt_pk_bf16_f32 v148, v88, v89
    v_cvt_pk_bf16_f32 v149, v90, v91
    v_cvt_pk_bf16_f32 v150, v92, v93
    v_cvt_pk_bf16_f32 v151, v94, v95
    s_add_u32 s47, s46, 196608
    buffer_store_dwordx4 v[148:151], v50, s[28:31], s47 offen
    v_cvt_pk_bf16_f32 v136, v96, v97
    v_cvt_pk_bf16_f32 v137, v98, v99
    v_cvt_pk_bf16_f32 v138, v100, v101
    v_cvt_pk_bf16_f32 v139, v102, v103
    s_add_u32 s47, s46, 1024
    buffer_store_dwordx4 v[136:139], v50, s[28:31], s47 offen
    v_cvt_pk_bf16_f32 v140, v104, v105
    v_cvt_pk_bf16_f32 v141, v106, v107
    v_cvt_pk_bf16_f32 v142, v108, v109
    v_cvt_pk_bf16_f32 v143, v110, v111
    s_add_u32 s47, s46, 66560
    buffer_store_dwordx4 v[140:143], v50, s[28:31], s47 offen
    v_cvt_pk_bf16_f32 v144, v112, v113
    v_cvt_pk_bf16_f32 v145, v114, v115
    v_cvt_pk_bf16_f32 v146, v116, v117
    v_cvt_pk_bf16_f32 v147, v118, v119
    s_add_u32 s47, s46, 132096
    buffer_store_dwordx4 v[144:147], v50, s[28:31], s47 offen
    v_cvt_pk_bf16_f32 v148, v120, v121
    v_cvt_pk_bf16_f32 v149, v122, v123
    v_cvt_pk_bf16_f32 v150, v124, v125
    v_cvt_pk_bf16_f32 v151, v126, v127
    s_add_u32 s47, s46, 197632
    buffer_store_dwordx4 v[148:151], v50, s[28:31], s47 offen
    s_endpgm
kA_epi_h:
    s_and_b32 s53, s51, 1
    s_lshr_b32 s54, s51, 1
    s_add_u32 s54, s54, 1
    s_sub_u32 s55, 0, s54
    s_cmp_eq_u32 s53, 0
    s_cselect_b32 s54, s54, s55
    s_lshl_b32 s46, s26, 7
    s_lshl_b32 s47, s38, 6
    s_add_u32 s46, s46, s47
    s_add_u32 s46, s46, s54
    v_and_b32 v4, 31, v2
    v_lshrrev_b32 v5, 5, v2
    v_lshlrev_b32 v5, 9, v5
    v_add_u32 v6, s46, v4
    v_mov_b32 v7, 0x800
    v_cmp_lt_u32 vcc, v6, v7
    v_mul_f32 v52, 1.0, v130
    v_mul_f32_e64 v53, -v128, v130
    v_cndmask_b32 v52, 0, v52, vcc
    v_cndmask_b32 v53, 0, v53, vcc
    v_and_b32 v6, 0x7ff, v6
    v_lshrrev_b32 v7, 5, v6
    v_lshlrev_b32 v7, 15, v7
    v_and_b32 v6, 31, v6
    v_lshl_add_u32 v6, v6, 4, v7
    v_add_u32 v14, v6, v5
    v_add_u32 v6, s46, v4
    v_add_u32 v6, 32, v6
    v_mov_b32 v7, 0x800
    v_cmp_lt_u32 vcc, v6, v7
    v_mul_f32 v54, 1.0, v134
    v_mul_f32_e64 v55, -v132, v134
    v_cndmask_b32 v54, 0, v54, vcc
    v_cndmask_b32 v55, 0, v55, vcc
    v_and_b32 v6, 0x7ff, v6
    v_lshrrev_b32 v7, 5, v6
    v_lshlrev_b32 v7, 15, v7
    v_and_b32 v6, 31, v6
    v_lshl_add_u32 v6, v6, 4, v7
    v_add_u32 v15, v6, v5
    s_waitcnt lgkmcnt(0)
    v_pk_mul_f32 v[56:57], v[16:17], v[52:53] op_sel:[0,1] op_sel_hi:[1,1]
    v_pk_mul_f32 v[58:59], v[18:19], v[52:53] op_sel:[0,1] op_sel_hi:[1,1]
    v_pk_mul_f32 v[60:61], v[20:21], v[52:53] op_sel:[0,1] op_sel_hi:[1,1]
    v_pk_mul_f32 v[62:63], v[22:23], v[52:53] op_sel:[0,1] op_sel_hi:[1,1]
    v_pk_fma_f32 v[64:65], v[64:65], v[52:53], v[56:57] op_sel_hi:[1,0,1]
    v_pk_mul_f32 v[56:57], v[24:25], v[52:53] op_sel:[0,1] op_sel_hi:[1,1]
    v_pk_fma_f32 v[66:67], v[66:67], v[52:53], v[58:59] op_sel_hi:[1,0,1]
    v_pk_mul_f32 v[58:59], v[26:27], v[52:53] op_sel:[0,1] op_sel_hi:[1,1]
    v_pk_fma_f32 v[68:69], v[68:69], v[52:53], v[60:61] op_sel_hi:[1,0,1]
    v_pk_mul_f32 v[60:61], v[28:29], v[52:53] op_sel:[0,1] op_sel_hi:[1,1]
    v_pk_fma_f32 v[70:71], v[70:71], v[52:53], v[62:63] op_sel_hi:[1,0,1]
    v_pk_mul_f32 v[62:63], v[30:31], v[52:53] op_sel:[0,1] op_sel_hi:[1,1]
    v_pk_fma_f32 v[72:73], v[72:73], v[52:53], v[56:57] op_sel_hi:[1,0,1]
    v_pk_fma_f32 v[74:75], v[74:75], v[52:53], v[58:59] op_sel_hi:[1,0,1]
    v_pk_fma_f32 v[76:77], v[76:77], v[52:53], v[60:61] op_sel_hi:[1,0,1]
    v_pk_fma_f32 v[78:79], v[78:79], v[52:53], v[62:63] op_sel_hi:[1,0,1]
    v_pk_mul_f32 v[56:57], v[32:33], v[52:53] op_sel:[0,1] op_sel_hi:[1,1]
    v_pk_mul_f32 v[58:59], v[34:35], v[52:53] op_sel:[0,1] op_sel_hi:[1,1]
    v_pk_mul_f32 v[60:61], v[36:37], v[52:53] op_sel:[0,1] op_sel_hi:[1,1]
    v_pk_mul_f32 v[62:63], v[38:39], v[52:53] op_sel:[0,1] op_sel_hi:[1,1]
    v_pk_fma_f32 v[80:81], v[80:81], v[52:53], v[56:57] op_sel_hi:[1,0,1]
    v_pk_mul_f32 v[56:57], v[40:41], v[52:53] op_sel:[0,1] op_sel_hi:[1,1]
    v_pk_fma_f32 v[82:83], v[82:83], v[52:53], v[58:59] op_sel_hi:[1,0,1]
    v_pk_mul_f32 v[58:59], v[42:43], v[52:53] op_sel:[0,1] op_sel_hi:[1,1]
    v_pk_fma_f32 v[84:85], v[84:85], v[52:53], v[60:61] op_sel_hi:[1,0,1]
    v_pk_mul_f32 v[60:61], v[44:45], v[52:53] op_sel:[0,1] op_sel_hi:[1,1]
    v_pk_fma_f32 v[86:87], v[86:87], v[52:53], v[62:63] op_sel_hi:[1,0,1]
    v_pk_mul_f32 v[62:63], v[46:47], v[52:53] op_sel:[0,1] op_sel_hi:[1,1]
    v_pk_fma_f32 v[88:89], v[88:89], v[52:53], v[56:57] op_sel_hi:[1,0,1]
    v_pk_fma_f32 v[90:91], v[90:91], v[52:53], v[58:59] op_sel_hi:[1,0,1]
    v_pk_fma_f32 v[92:93], v[92:93], v[52:53], v[60:61] op_sel_hi:[1,0,1]
    v_pk_fma_f32 v[94:95], v[94:95], v[52:53], v[62:63] op_sel_hi:[1,0,1]
    v_pk_mul_f32 v[56:57], v[16:17], v[54:55] op_sel:[0,1] op_sel_hi:[1,1]
    v_pk_mul_f32 v[58:59], v[18:19], v[54:55] op_sel:[0,1] op_sel_hi:[1,1]
    v_pk_mul_f32 v[60:61], v[20:21], v[54:55] op_sel:[0,1] op_sel_hi:[1,1]
    v_pk_mul_f32 v[62:63], v[22:23], v[54:55] op_sel:[0,1] op_sel_hi:[1,1]
    v_pk_fma_f32 v[96:97], v[96:97], v[54:55], v[56:57] op_sel_hi:[1,0,1]
    v_pk_mul_f32 v[56:57], v[24:25], v[54:55] op_sel:[0,1] op_sel_hi:[1,1]
    v_pk_fma_f32 v[98:99], v[98:99], v[54:55], v[58:59] op_sel_hi:[1,0,1]
    v_pk_mul_f32 v[58:59], v[26:27], v[54:55] op_sel:[0,1] op_sel_hi:[1,1]
    v_pk_fma_f32 v[100:101], v[100:101], v[54:55], v[60:61] op_sel_hi:[1,0,1]
    v_pk_mul_f32 v[60:61], v[28:29], v[54:55] op_sel:[0,1] op_sel_hi:[1,1]
    v_pk_fma_f32 v[102:103], v[102:103], v[54:55], v[62:63] op_sel_hi:[1,0,1]
    v_pk_mul_f32 v[62:63], v[30:31], v[54:55] op_sel:[0,1] op_sel_hi:[1,1]
    v_pk_fma_f32 v[104:105], v[104:105], v[54:55], v[56:57] op_sel_hi:[1,0,1]
    v_pk_fma_f32 v[106:107], v[106:107], v[54:55], v[58:59] op_sel_hi:[1,0,1]
    v_pk_fma_f32 v[108:109], v[108:109], v[54:55], v[60:61] op_sel_hi:[1,0,1]
    v_pk_fma_f32 v[110:111], v[110:111], v[54:55], v[62:63] op_sel_hi:[1,0,1]
    v_pk_mul_f32 v[56:57], v[32:33], v[54:55] op_sel:[0,1] op_sel_hi:[1,1]
    v_pk_mul_f32 v[58:59], v[34:35], v[54:55] op_sel:[0,1] op_sel_hi:[1,1]
    v_pk_mul_f32 v[60:61], v[36:37], v[54:55] op_sel:[0,1] op_sel_hi:[1,1]
    v_pk_mul_f32 v[62:63], v[38:39], v[54:55] op_sel:[0,1] op_sel_hi:[1,1]
    v_pk_fma_f32 v[112:113], v[112:113], v[54:55], v[56:57] op_sel_hi:[1,0,1]
    v_pk_mul_f32 v[56:57], v[40:41], v[54:55] op_sel:[0,1] op_sel_hi:[1,1]
    v_pk_fma_f32 v[114:115], v[114:115], v[54:55], v[58:59] op_sel_hi:[1,0,1]
    v_pk_mul_f32 v[58:59], v[42:43], v[54:55] op_sel:[0,1] op_sel_hi:[1,1]
    v_pk_fma_f32 v[116:117], v[116:117], v[54:55], v[60:61] op_sel_hi:[1,0,1]
    v_pk_mul_f32 v[60:61], v[44:45], v[54:55] op_sel:[0,1] op_sel_hi:[1,1]
    v_pk_fma_f32 v[118:119], v[118:119], v[54:55], v[62:63] op_sel_hi:[1,0,1]
    v_pk_mul_f32 v[62:63], v[46:47], v[54:55] op_sel:[0,1] op_sel_hi:[1,1]
    v_pk_fma_f32 v[120:121], v[120:121], v[54:55], v[56:57] op_sel_hi:[1,0,1]
    v_pk_fma_f32 v[122:123], v[122:123], v[54:55], v[58:59] op_sel_hi:[1,0,1]
    v_pk_fma_f32 v[124:125], v[124:125], v[54:55], v[60:61] op_sel_hi:[1,0,1]
    v_pk_fma_f32 v[126:127], v[126:127], v[54:55], v[62:63] op_sel_hi:[1,0,1]
    v_mov_b32 v4, 0xbdd2d3e8
    v_mov_b32 v5, 0xc0135761
    v_mov_b32 v6, 1.0
    v_mov_b32 v7, 1.0
    s_lshl_b32 s47, s51, 3
    s_lshl_b32 s53, s39, 2
    s_add_u32 s47, s47, s53
    s_lshl_b32 s47, s47, 10
    s_add_u32 s46, s47, 0x600000
    v_pk_mul_f32 v[16:17], v[64:65], v[64:65]
    v_pk_mul_f32 v[18:19], v[66:67], v[66:67]
    v_pk_mul_f32 v[20:21], v[68:69], v[68:69]
    v_pk_mul_f32 v[22:23], v[70:71], v[70:71]
    v_pk_mul_f32 v[24:25], v[72:73], v[72:73]
    v_pk_mul_f32 v[26:27], v[74:75], v[74:75]
    v_pk_mul_f32 v[28:29], v[76:77], v[76:77]
    v_pk_mul_f32 v[30:31], v[78:79], v[78:79]
    v_pk_fma_f32 v[16:17], v[16:17], v[4:5], v[4:5] op_sel:[0,0,1] op_sel_hi:[1,0,1]
    v_pk_fma_f32 v[18:19], v[18:19], v[4:5], v[4:5] op_sel:[0,0,1] op_sel_hi:[1,0,1]
    v_pk_fma_f32 v[20:21], v[20:21], v[4:5], v[4:5] op_sel:[0,0,1] op_sel_hi:[1,0,1]
    v_pk_fma_f32 v[22:23], v[22:23], v[4:5], v[4:5] op_sel:[0,0,1] op_sel_hi:[1,0,1]
    v_pk_fma_f32 v[24:25], v[24:25], v[4:5], v[4:5] op_sel:[0,0,1] op_sel_hi:[1,0,1]
    v_pk_fma_f32 v[26:27], v[26:27], v[4:5], v[4:5] op_sel:[0,0,1] op_sel_hi:[1,0,1]
    v_pk_fma_f32 v[28:29], v[28:29], v[4:5], v[4:5] op_sel:[0,0,1] op_sel_hi:[1,0,1]
    v_pk_fma_f32 v[30:31], v[30:31], v[4:5], v[4:5] op_sel:[0,0,1] op_sel_hi:[1,0,1]
    v_pk_mul_f32 v[16:17], v[16:17], v[64:65]
    v_pk_mul_f32 v[18:19], v[18:19], v[66:67]
    v_pk_mul_f32 v[20:21], v[20:21], v[68:69]
    v_pk_mul_f32 v[22:23], v[22:23], v[70:71]
    v_pk_mul_f32 v[24:25], v[24:25], v[72:73]
    v_pk_mul_f32 v[26:27], v[26:27], v[74:75]
    v_pk_mul_f32 v[28:29], v[28:29], v[76:77]
    v_pk_mul_f32 v[30:31], v[30:31], v[78:79]
    v_exp_f32 v16, v16
    v_exp_f32 v17, v17
    v_exp_f32 v18, v18
    v_exp_f32 v19, v19
    v_exp_f32 v20, v20
    v_exp_f32 v21, v21
    v_exp_f32 v22, v22
    v_exp_f32 v23, v23
    v_exp_f32 v24, v24
    v_exp_f32 v25, v25
    v_exp_f32 v26, v26
    v_exp_f32 v27, v27
    v_exp_f32 v28, v28
    v_exp_f32 v29, v29
    v_exp_f32 v30, v30
    v_exp_f32 v31, v31
    v_pk_add_f32 v[16:17], v[16:17], v[6:7]
    v_pk_add_f32 v[18:19], v[18:19], v[6:7]
    v_pk_add_f32 v[20:21], v[20:21], v[6:7]
    v_pk_add_f32 v[22:23], v[22:23], v[6:7]
    v_pk_add_f32 v[24:25], v[24:25], v[6:7]
    v_pk_add_f32 v[26:27], v[26:27], v[6:7]
    v_pk_add_f32 v[28:29], v[28:29], v[6:7]
    v_pk_add_f32 v[30:31], v[30:31], v[6:7]
    v_rcp_f32 v16, v16
    v_rcp_f32 v17, v17
    v_rcp_f32 v18, v18
    v_rcp_f32 v19, v19
    v_rcp_f32 v20, v20
    v_rcp_f32 v21, v21
    v_rcp_f32 v22, v22
    v_rcp_f32 v23, v23
    v_rcp_f32 v24, v24
    v_rcp_f32 v25, v25
    v_rcp_f32 v26, v26
    v_rcp_f32 v27, v27
    v_rcp_f32 v28, v28
    v_rcp_f32 v29, v29
    v_rcp_f32 v30, v30
    v_rcp_f32 v31, v31
    v_pk_mul_f32 v[64:65], v[64:65], v[16:17]
    v_pk_mul_f32 v[66:67], v[66:67], v[18:19]
    v_pk_mul_f32 v[68:69], v[68:69], v[20:21]
    v_pk_mul_f32 v[70:71], v[70:71], v[22:23]
    v_pk_mul_f32 v[72:73], v[72:73], v[24:25]
    v_pk_mul_f32 v[74:75], v[74:75], v[26:27]
    v_pk_mul_f32 v[76:77], v[76:77], v[28:29]
    v_pk_mul_f32 v[78:79], v[78:79], v[30:31]
    v_cvt_pk_bf16_f32 v136, v64, v65
    v_cvt_pk_bf16_f32 v137, v66, v67
    v_cvt_pk_bf16_f32 v138, v68, v69
    v_cvt_pk_bf16_f32 v139, v70, v71
    s_add_u32 s47, s46, 0
    buffer_store_dwordx4 v[136:139], v14, s[28:31], s47 offen
    v_cvt_pk_bf16_f32 v140, v72, v73
    v_cvt_pk_bf16_f32 v141, v74, v75
    v_cvt_pk_bf16_f32 v142, v76, v77
    v_cvt_pk_bf16_f32 v143, v78, v79
    s_add_u32 s47, s46, 1024
    buffer_store_dwordx4 v[140:143], v14, s[28:31], s47 offen
    v_pk_mul_f32 v[16:17], v[80:81], v[80:81]
    v_pk_mul_f32 v[18:19], v[82:83], v[82:83]
    v_pk_mul_f32 v[20:21], v[84:85], v[84:85]
    v_pk_mul_f32 v[22:23], v[86:87], v[86:87]
    v_pk_mul_f32 v[24:25], v[88:89], v[88:89]
    v_pk_mul_f32 v[26:27], v[90:91], v[90:91]
    v_pk_mul_f32 v[28:29], v[92:93], v[92:93]
    v_pk_mul_f32 v[30:31], v[94:95], v[94:95]
    v_pk_fma_f32 v[16:17], v[16:17], v[4:5], v[4:5] op_sel:[0,0,1] op_sel_hi:[1,0,1]
    v_pk_fma_f32 v[18:19], v[18:19], v[4:5], v[4:5] op_sel:[0,0,1] op_sel_hi:[1,0,1]
    v_pk_fma_f32 v[20:21], v[20:21], v[4:5], v[4:5] op_sel:[0,0,1] op_sel_hi:[1,0,1]
    v_pk_fma_f32 v[22:23], v[22:23], v[4:5], v[4:5] op_sel:[0,0,1] op_sel_hi:[1,0,1]
    v_pk_fma_f32 v[24:25], v[24:25], v[4:5], v[4:5] op_sel:[0,0,1] op_sel_hi:[1,0,1]
    v_pk_fma_f32 v[26:27], v[26:27], v[4:5], v[4:5] op_sel:[0,0,1] op_sel_hi:[1,0,1]
    v_pk_fma_f32 v[28:29], v[28:29], v[4:5], v[4:5] op_sel:[0,0,1] op_sel_hi:[1,0,1]
    v_pk_fma_f32 v[30:31], v[30:31], v[4:5], v[4:5] op_sel:[0,0,1] op_sel_hi:[1,0,1]
    v_pk_mul_f32 v[16:17], v[16:17], v[80:81]
    v_pk_mul_f32 v[18:19], v[18:19], v[82:83]
    v_pk_mul_f32 v[20:21], v[20:21], v[84:85]
    v_pk_mul_f32 v[22:23], v[22:23], v[86:87]
    v_pk_mul_f32 v[24:25], v[24:25], v[88:89]
    v_pk_mul_f32 v[26:27], v[26:27], v[90:91]
    v_pk_mul_f32 v[28:29], v[28:29], v[92:93]
    v_pk_mul_f32 v[30:31], v[30:31], v[94:95]
    v_exp_f32 v16, v16
    v_exp_f32 v17, v17
    v_exp_f32 v18, v18
    v_exp_f32 v19, v19
    v_exp_f32 v20, v20
    v_exp_f32 v21, v21
    v_exp_f32 v22, v22
    v_exp_f32 v23, v23
    v_exp_f32 v24, v24
    v_exp_f32 v25, v25
    v_exp_f32 v26, v26
    v_exp_f32 v27, v27
    v_exp_f32 v28, v28
    v_exp_f32 v29, v29
    v_exp_f32 v30, v30
    v_exp_f32 v31, v31
    v_pk_add_f32 v[16:17], v[16:17], v[6:7]
    v_pk_add_f32 v[18:19], v[18:19], v[6:7]
    v_pk_add_f32 v[20:21], v[20:21], v[6:7]
    v_pk_add_f32 v[22:23], v[22:23], v[6:7]
    v_pk_add_f32 v[24:25], v[24:25], v[6:7]
    v_pk_add_f32 v[26:27], v[26:27], v[6:7]
    v_pk_add_f32 v[28:29], v[28:29], v[6:7]
    v_pk_add_f32 v[30:31], v[30:31], v[6:7]
    v_rcp_f32 v16, v16
    v_rcp_f32 v17, v17
    v_rcp_f32 v18, v18
    v_rcp_f32 v19, v19
    v_rcp_f32 v20, v20
    v_rcp_f32 v21, v21
    v_rcp_f32 v22, v22
    v_rcp_f32 v23, v23
    v_rcp_f32 v24, v24
    v_rcp_f32 v25, v25
    v_rcp_f32 v26, v26
    v_rcp_f32 v27, v27
    v_rcp_f32 v28, v28
    v_rcp_f32 v29, v29
    v_rcp_f32 v30, v30
    v_rcp_f32 v31, v31
    v_pk_mul_f32 v[80:81], v[80:81], v[16:17]
    v_pk_mul_f32 v[82:83], v[82:83], v[18:19]
    v_pk_mul_f32 v[84:85], v[84:85], v[20:21]
    v_pk_mul_f32 v[86:87], v[86:87], v[22:23]
    v_pk_mul_f32 v[88:89], v[88:89], v[24:25]
    v_pk_mul_f32 v[90:91], v[90:91], v[26:27]
    v_pk_mul_f32 v[92:93], v[92:93], v[28:29]
    v_pk_mul_f32 v[94:95], v[94:95], v[30:31]
    v_cvt_pk_bf16_f32 v144, v80, v81
    v_cvt_pk_bf16_f32 v145, v82, v83
    v_cvt_pk_bf16_f32 v146, v84, v85
    v_cvt_pk_bf16_f32 v147, v86, v87
    s_add_u32 s47, s46, 2048
    buffer_store_dwordx4 v[144:147], v14, s[28:31], s47 offen
    v_cvt_pk_bf16_f32 v148, v88, v89
    v_cvt_pk_bf16_f32 v149, v90, v91
    v_cvt_pk_bf16_f32 v150, v92, v93
    v_cvt_pk_bf16_f32 v151, v94, v95
    s_add_u32 s47, s46, 3072
    buffer_store_dwordx4 v[148:151], v14, s[28:31], s47 offen
    v_pk_mul_f32 v[16:17], v[96:97], v[96:97]
    v_pk_mul_f32 v[18:19], v[98:99], v[98:99]
    v_pk_mul_f32 v[20:21], v[100:101], v[100:101]
    v_pk_mul_f32 v[22:23], v[102:103], v[102:103]
    v_pk_mul_f32 v[24:25], v[104:105], v[104:105]
    v_pk_mul_f32 v[26:27], v[106:107], v[106:107]
    v_pk_mul_f32 v[28:29], v[108:109], v[108:109]
    v_pk_mul_f32 v[30:31], v[110:111], v[110:111]
    v_pk_fma_f32 v[16:17], v[16:17], v[4:5], v[4:5] op_sel:[0,0,1] op_sel_hi:[1,0,1]
    v_pk_fma_f32 v[18:19], v[18:19], v[4:5], v[4:5] op_sel:[0,0,1] op_sel_hi:[1,0,1]
    v_pk_fma_f32 v[20:21], v[20:21], v[4:5], v[4:5] op_sel:[0,0,1] op_sel_hi:[1,0,1]
    v_pk_fma_f32 v[22:23], v[22:23], v[4:5], v[4:5] op_sel:[0,0,1] op_sel_hi:[1,0,1]
    v_pk_fma_f32 v[24:25], v[24:25], v[4:5], v[4:5] op_sel:[0,0,1] op_sel_hi:[1,0,1]
    v_pk_fma_f32 v[26:27], v[26:27], v[4:5], v[4:5] op_sel:[0,0,1] op_sel_hi:[1,0,1]
    v_pk_fma_f32 v[28:29], v[28:29], v[4:5], v[4:5] op_sel:[0,0,1] op_sel_hi:[1,0,1]
    v_pk_fma_f32 v[30:31], v[30:31], v[4:5], v[4:5] op_sel:[0,0,1] op_sel_hi:[1,0,1]
    v_pk_mul_f32 v[16:17], v[16:17], v[96:97]
    v_pk_mul_f32 v[18:19], v[18:19], v[98:99]
    v_pk_mul_f32 v[20:21], v[20:21], v[100:101]
    v_pk_mul_f32 v[22:23], v[22:23], v[102:103]
    v_pk_mul_f32 v[24:25], v[24:25], v[104:105]
    v_pk_mul_f32 v[26:27], v[26:27], v[106:107]
    v_pk_mul_f32 v[28:29], v[28:29], v[108:109]
    v_pk_mul_f32 v[30:31], v[30:31], v[110:111]
    v_exp_f32 v16, v16
    v_exp_f32 v17, v17
    v_exp_f32 v18, v18
    v_exp_f32 v19, v19
    v_exp_f32 v20, v20
    v_exp_f32 v21, v21
    v_exp_f32 v22, v22
    v_exp_f32 v23, v23
    v_exp_f32 v24, v24
    v_exp_f32 v25, v25
    v_exp_f32 v26, v26
    v_exp_f32 v27, v27
    v_exp_f32 v28, v28
    v_exp_f32 v29, v29
    v_exp_f32 v30, v30
    v_exp_f32 v31, v31
    v_pk_add_f32 v[16:17], v[16:17], v[6:7]
    v_pk_add_f32 v[18:19], v[18:19], v[6:7]
    v_pk_add_f32 v[20:21], v[20:21], v[6:7]
    v_pk_add_f32 v[22:23], v[22:23], v[6:7]
    v_pk_add_f32 v[24:25], v[24:25], v[6:7]
    v_pk_add_f32 v[26:27], v[26:27], v[6:7]
    v_pk_add_f32 v[28:29], v[28:29], v[6:7]
    v_pk_add_f32 v[30:31], v[30:31], v[6:7]
    v_rcp_f32 v16, v16
    v_rcp_f32 v17, v17
    v_rcp_f32 v18, v18
    v_rcp_f32 v19, v19
    v_rcp_f32 v20, v20
    v_rcp_f32 v21, v21
    v_rcp_f32 v22, v22
    v_rcp_f32 v23, v23
    v_rcp_f32 v24, v24
    v_rcp_f32 v25, v25
    v_rcp_f32 v26, v26
    v_rcp_f32 v27, v27
    v_rcp_f32 v28, v28
    v_rcp_f32 v29, v29
    v_rcp_f32 v30, v30
    v_rcp_f32 v31, v31
    v_pk_mul_f32 v[96:97], v[96:97], v[16:17]
    v_pk_mul_f32 v[98:99], v[98:99], v[18:19]
    v_pk_mul_f32 v[100:101], v[100:101], v[20:21]
    v_pk_mul_f32 v[102:103], v[102:103], v[22:23]
    v_pk_mul_f32 v[104:105], v[104:105], v[24:25]
    v_pk_mul_f32 v[106:107], v[106:107], v[26:27]
    v_pk_mul_f32 v[108:109], v[108:109], v[28:29]
    v_pk_mul_f32 v[110:111], v[110:111], v[30:31]
    v_cvt_pk_bf16_f32 v136, v96, v97
    v_cvt_pk_bf16_f32 v137, v98, v99
    v_cvt_pk_bf16_f32 v138, v100, v101
    v_cvt_pk_bf16_f32 v139, v102, v103
    s_add_u32 s47, s46, 0
    buffer_store_dwordx4 v[136:139], v15, s[28:31], s47 offen
    v_cvt_pk_bf16_f32 v140, v104, v105
    v_cvt_pk_bf16_f32 v141, v106, v107
    v_cvt_pk_bf16_f32 v142, v108, v109
    v_cvt_pk_bf16_f32 v143, v110, v111
    s_add_u32 s47, s46, 1024
    buffer_store_dwordx4 v[140:143], v15, s[28:31], s47 offen
    v_pk_mul_f32 v[16:17], v[112:113], v[112:113]
    v_pk_mul_f32 v[18:19], v[114:115], v[114:115]
    v_pk_mul_f32 v[20:21], v[116:117], v[116:117]
    v_pk_mul_f32 v[22:23], v[118:119], v[118:119]
    v_pk_mul_f32 v[24:25], v[120:121], v[120:121]
    v_pk_mul_f32 v[26:27], v[122:123], v[122:123]
    v_pk_mul_f32 v[28:29], v[124:125], v[124:125]
    v_pk_mul_f32 v[30:31], v[126:127], v[126:127]
    v_pk_fma_f32 v[16:17], v[16:17], v[4:5], v[4:5] op_sel:[0,0,1] op_sel_hi:[1,0,1]
    v_pk_fma_f32 v[18:19], v[18:19], v[4:5], v[4:5] op_sel:[0,0,1] op_sel_hi:[1,0,1]
    v_pk_fma_f32 v[20:21], v[20:21], v[4:5], v[4:5] op_sel:[0,0,1] op_sel_hi:[1,0,1]
    v_pk_fma_f32 v[22:23], v[22:23], v[4:5], v[4:5] op_sel:[0,0,1] op_sel_hi:[1,0,1]
    v_pk_fma_f32 v[24:25], v[24:25], v[4:5], v[4:5] op_sel:[0,0,1] op_sel_hi:[1,0,1]
    v_pk_fma_f32 v[26:27], v[26:27], v[4:5], v[4:5] op_sel:[0,0,1] op_sel_hi:[1,0,1]
    v_pk_fma_f32 v[28:29], v[28:29], v[4:5], v[4:5] op_sel:[0,0,1] op_sel_hi:[1,0,1]
    v_pk_fma_f32 v[30:31], v[30:31], v[4:5], v[4:5] op_sel:[0,0,1] op_sel_hi:[1,0,1]
    v_pk_mul_f32 v[16:17], v[16:17], v[112:113]
    v_pk_mul_f32 v[18:19], v[18:19], v[114:115]
    v_pk_mul_f32 v[20:21], v[20:21], v[116:117]
    v_pk_mul_f32 v[22:23], v[22:23], v[118:119]
    v_pk_mul_f32 v[24:25], v[24:25], v[120:121]
    v_pk_mul_f32 v[26:27], v[26:27], v[122:123]
    v_pk_mul_f32 v[28:29], v[28:29], v[124:125]
    v_pk_mul_f32 v[30:31], v[30:31], v[126:127]
    v_exp_f32 v16, v16
    v_exp_f32 v17, v17
    v_exp_f32 v18, v18
    v_exp_f32 v19, v19
    v_exp_f32 v20, v20
    v_exp_f32 v21, v21
    v_exp_f32 v22, v22
    v_exp_f32 v23, v23
    v_exp_f32 v24, v24
    v_exp_f32 v25, v25
    v_exp_f32 v26, v26
    v_exp_f32 v27, v27
    v_exp_f32 v28, v28
    v_exp_f32 v29, v29
    v_exp_f32 v30, v30
    v_exp_f32 v31, v31
    v_pk_add_f32 v[16:17], v[16:17], v[6:7]
    v_pk_add_f32 v[18:19], v[18:19], v[6:7]
    v_pk_add_f32 v[20:21], v[20:21], v[6:7]
    v_pk_add_f32 v[22:23], v[22:23], v[6:7]
    v_pk_add_f32 v[24:25], v[24:25], v[6:7]
    v_pk_add_f32 v[26:27], v[26:27], v[6:7]
    v_pk_add_f32 v[28:29], v[28:29], v[6:7]
    v_pk_add_f32 v[30:31], v[30:31], v[6:7]
    v_rcp_f32 v16, v16
    v_rcp_f32 v17, v17
    v_rcp_f32 v18, v18
    v_rcp_f32 v19, v19
    v_rcp_f32 v20, v20
    v_rcp_f32 v21, v21
    v_rcp_f32 v22, v22
    v_rcp_f32 v23, v23
    v_rcp_f32 v24, v24
    v_rcp_f32 v25, v25
    v_rcp_f32 v26, v26
    v_rcp_f32 v27, v27
    v_rcp_f32 v28, v28
    v_rcp_f32 v29, v29
    v_rcp_f32 v30, v30
    v_rcp_f32 v31, v31
    v_pk_mul_f32 v[112:113], v[112:113], v[16:17]
    v_pk_mul_f32 v[114:115], v[114:115], v[18:19]
    v_pk_mul_f32 v[116:117], v[116:117], v[20:21]
    v_pk_mul_f32 v[118:119], v[118:119], v[22:23]
    v_pk_mul_f32 v[120:121], v[120:121], v[24:25]
    v_pk_mul_f32 v[122:123], v[122:123], v[26:27]
    v_pk_mul_f32 v[124:125], v[124:125], v[28:29]
    v_pk_mul_f32 v[126:127], v[126:127], v[30:31]
    v_cvt_pk_bf16_f32 v144, v112, v113
    v_cvt_pk_bf16_f32 v145, v114, v115
    v_cvt_pk_bf16_f32 v146, v116, v117
    v_cvt_pk_bf16_f32 v147, v118, v119
    s_add_u32 s47, s46, 2048
    buffer_store_dwordx4 v[144:147], v15, s[28:31], s47 offen
    v_cvt_pk_bf16_f32 v148, v120, v121
    v_cvt_pk_bf16_f32 v149, v122, v123
    v_cvt_pk_bf16_f32 v150, v124, v125
    v_cvt_pk_bf16_f32 v151, v126, v127
    s_add_u32 s47, s46, 3072
    buffer_store_dwordx4 v[148:151], v15, s[28:31], s47 offen
kA_done:
    s_endpgm
.globl kB_kernel
.p2align 8
.type kB_kernel,@function
kB_kernel:
    s_cmp_ge_u32 s2, 256
    s_cbranch_scc1 kB_done
    s_load_dwordx2 s[4:5], s[0:1], 0
    s_load_dwordx2 s[22:23], s[0:1], 80
    v_lshrrev_b32 v1, 6, v0
    v_and_b32 v2, 63, v0
    v_readfirstlane_b32 s33, v1
    s_and_b32 s24, s2, 7
    s_lshr_b32 s25, s2, 3
    s_cmp_lt_u32 s33, 8
    s_cbranch_scc1 kB_attn
    s_sub_u32 s33, s33, 8
    s_lshr_b32 s26, s25, 3
    s_lshl_b32 s27, s24, 2
    s_add_u32 s26, s26, s27
    s_and_b32 s27, s25, 7
    s_lshl_b32 s35, s33, 3
    v_lshlrev_b32 v4, 4, v2
    s_cmp_lg_u32 s33, 0
    s_cbranch_scc1 kB_24
    v_mov_b32 v5, 82944
    v_mov_b32 v6, 0
    ds_write_b32 v5, v6
kB_24:
    s_waitcnt lgkmcnt(0)
    s_mov_b32 s8, s4
    s_mov_b32 s9, s5
    s_mov_b32 s10, 0x200000
    s_mov_b32 s11, 0x20000
    s_mov_b32 s28, s22
    s_mov_b32 s29, s23
    s_mov_b32 s30, 0x10000000
    s_mov_b32 s31, 0x20000
    s_and_b32 s37, s26, 3
    s_lshl_b32 s38, s37, 1
    s_add_u32 s38, s38, s27
    s_and_b32 s38, s38, 7
    s_mov_b32 s38, 0
    s_lshl_b32 s50, s26, 1
    s_mul_i32 s50, s50, 32
    s_add_u32 s50, s50, s35
    s_lshl_b32 s50, s50, 10
    s_add_u32 s50, s50, 0x600000
    s_add_u32 s51, s50, 0x8000
    s_lshl_b32 s52, s27, 1
    s_mul_i32 s52, s52, 32
    s_add_u32 s52, s52, s35
    s_lshl_b32 s52, s52, 10
    s_add_u32 s52, s52, 0x1700000
    s_add_u32 s53, s52, 0x8000
    s_lshl_b32 s55, s38, 10
    v_add_u32 v5, s55, v4
    buffer_load_dwordx4 v[24:27], v5, s[28:31], s52 offen
    buffer_load_dwordx4 v[16:19], v5, s[28:31], s50 offen
    buffer_load_dwordx4 v[20:23], v5, s[28:31], s51 offen
    buffer_load_dwordx4 v[28:31], v5, s[28:31], s53 offen
    s_add_u32 s55, s55, 1024
    s_cmp_eq_u32 s55, 8192
    s_cselect_b32 s55, 0, s55
    v_add_u32 v5, s55, v4
    buffer_load_dwordx4 v[40:43], v5, s[28:31], s52 offen
    buffer_load_dwordx4 v[32:35], v5, s[28:31], s50 offen
    buffer_load_dwordx4 v[36:39], v5, s[28:31], s51 offen
    buffer_load_dwordx4 v[44:47], v5, s[28:31], s53 offen
    s_add_u32 s55, s55, 1024
    s_cmp_eq_u32 s55, 8192
    s_cselect_b32 s55, 0, s55
    v_add_u32 v5, s55, v4
    buffer_load_dwordx4 v[56:59], v5, s[28:31], s52 offen
    buffer_load_dwordx4 v[48:51], v5, s[28:31], s50 offen
    buffer_load_dwordx4 v[52:55], v5, s[28:31], s51 offen
    buffer_load_dwordx4 v[60:63], v5, s[28:31], s53 offen
    s_lshr_b32 s40, s33, 1
    s_and_b32 s41, s33, 1
    s_lshl_b32 s42, s26, 6
    s_lshl_b32 s43, s40, 5
    s_add_u32 s42, s42, s43
    s_lshl_b32 s43, s27, 6
    s_lshl_b32 s44, s41, 5
    s_add_u32 s43, s43, s44
    v_and_b32 v12, 31, v2
    v_lshrrev_b32 v13, 5, v2
    v_lshlrev_b32 v14, 10, v12
    v_lshl_add_u32 v14, v13, 3, v14
    s_lshl_b32 s44, s42, 10
    s_lshl_b32 s45, s43, 1
    s_add_u32 s44, s44, s45
    buffer_load_dwordx2 v[144:145], v14, s[8:11], s44 offen offset:0
    buffer_load_dwordx2 v[146:147], v14, s[8:11], s44 offen offset:16
    buffer_load_dwordx2 v[148:149], v14, s[8:11], s44 offen offset:32
    buffer_load_dwordx2 v[150:151], v14, s[8:11], s44 offen offset:48
    v_lshlrev_b32 v15, 4, v12
    s_lshl_b32 s45, s42, 4
    s_add_u32 s45, s45, 0x1400000
    buffer_load_dwordx2 v[152:153], v15, s[28:31], s45 offen
    s_barrier
    s_waitcnt vmcnt(13)
    v_mfma_f32_32x32x16_bf16 v[80:95], v[24:27], v[16:19], 0
    s_add_u32 s55, s55, 1024
    s_cmp_eq_u32 s55, 8192
    s_cselect_b32 s55, 0, s55
    v_add_u32 v5, s55, v4
    buffer_load_dwordx4 v[72:75], v5, s[28:31], s52 offen
    v_mfma_f32_32x32x16_bf16 v[112:127], v[24:27], v[20:23], 0
    buffer_load_dwordx4 v[64:67], v5, s[28:31], s50 offen
    v_mfma_f32_32x32x16_bf16 v[96:111], v[28:31], v[16:19], 0
    buffer_load_dwordx4 v[68:71], v5, s[28:31], s51 offen
    v_mfma_f32_32x32x16_bf16 v[128:143], v[28:31], v[20:23], 0
    buffer_load_dwordx4 v[76:79], v5, s[28:31], s53 offen
    s_waitcnt vmcnt(13)
    v_mfma_f32_32x32x16_bf16 v[80:95], v[40:43], v[32:35], v[80:95]
    s_add_u32 s55, s55, 1024
    s_cmp_eq_u32 s55, 8192
    s_cselect_b32 s55, 0, s55
    v_add_u32 v5, s55, v4
    buffer_load_dwordx4 v[24:27], v5, s[28:31], s52 offen
    v_mfma_f32_32x32x16_bf16 v[112:127], v[40:43], v[36:39], v[112:127]
    buffer_load_dwordx4 v[16:19], v5, s[28:31], s50 offen
    v_mfma_f32_32x32x16_bf16 v[96:111], v[44:47], v[32:35], v[96:111]
    buffer_load_dwordx4 v[20:23], v5, s[28:31], s51 offen
    v_mfma_f32_32x32x16_bf16 v[128:143], v[44:47], v[36:39], v[128:143]
    buffer_load_dwordx4 v[28:31], v5, s[28:31], s53 offen
    s_waitcnt vmcnt(13)
    v_mfma_f32_32x32x16_bf16 v[80:95], v[56:59], v[48:51], v[80:95]
    s_add_u32 s55, s55, 1024
    s_cmp_eq_u32 s55, 8192
    s_cselect_b32 s55, 0, s55
    v_add_u32 v5, s55, v4
    buffer_load_dwordx4 v[40:43], v5, s[28:31], s52 offen
    v_mfma_f32_32x32x16_bf16 v[112:127], v[56:59], v[52:55], v[112:127]
    buffer_load_dwordx4 v[32:35], v5, s[28:31], s50 offen
    v_mfma_f32_32x32x16_bf16 v[96:111], v[60:63], v[48:51], v[96:111]
    buffer_load_dwordx4 v[36:39], v5, s[28:31], s51 offen
    v_mfma_f32_32x32x16_bf16 v[128:143], v[60:63], v[52:55], v[128:143]
    buffer_load_dwordx4 v[44:47], v5, s[28:31], s53 offen
    s_waitcnt vmcnt(8)
    v_mfma_f32_32x32x16_bf16 v[80:95], v[72:75], v[64:67], v[80:95]
    s_add_u32 s55, s55, 1024
    s_cmp_eq_u32 s55, 8192
    s_cselect_b32 s55, 0, s55
    v_add_u32 v5, s55, v4
    buffer_load_dwordx4 v[56:59], v5, s[28:31], s52 offen
    v_mfma_f32_32x32x16_bf16 v[112:127], v[72:75], v[68:71], v[112:127]
    buffer_load_dwordx4 v[48:51], v5, s[28:31], s50 offen
    v_mfma_f32_32x32x16_bf16 v[96:111], v[76:79], v[64:67], v[96:111]
    buffer_load_dwordx4 v[52:55], v5, s[28:31], s51 offen
    v_mfma_f32_32x32x16_bf16 v[128:143], v[76:79], v[68:71], v[128:143]
    buffer_load_dwordx4 v[60:63], v5, s[28:31], s53 offen
    s_waitcnt vmcnt(8)
    v_mfma_f32_32x32x16_bf16 v[80:95], v[24:27], v[16:19], v[80:95]
    s_add_u32 s55, s55, 1024
    s_cmp_eq_u32 s55, 8192
    s_cselect_b32 s55, 0, s55
    v_add_u32 v5, s55, v4
    buffer_load_dwordx4 v[72:75], v5, s[28:31], s52 offen
    v_mfma_f32_32x32x16_bf16 v[112:127], v[24:27], v[20:23], v[112:127]
    buffer_load_dwordx4 v[64:67], v5, s[28:31], s50 offen
    v_mfma_f32_32x32x16_bf16 v[96:111], v[28:31], v[16:19], v[96:111]
    buffer_load_dwordx4 v[68:71], v5, s[28:31], s51 offen
    v_mfma_f32_32x32x16_bf16 v[128:143], v[28:31], v[20:23], v[128:143]
    buffer_load_dwordx4 v[76:79], v5, s[28:31], s53 offen
    s_waitcnt vmcnt(8)
    v_mfma_f32_32x32x16_bf16 v[80:95], v[40:43], v[32:35], v[80:95]
    v_mfma_f32_32x32x16_bf16 v[112:127], v[40:43], v[36:39], v[112:127]
    v_mfma_f32_32x32x16_bf16 v[96:111], v[44:47], v[32:35], v[96:111]
    v_mfma_f32_32x32x16_bf16 v[128:143], v[44:47], v[36:39], v[128:143]
    s_waitcnt vmcnt(4)
    v_mfma_f32_32x32x16_bf16 v[80:95], v[56:59], v[48:51], v[80:95]
    v_mfma_f32_32x32x16_bf16 v[112:127], v[56:59], v[52:55], v[112:127]
    v_mfma_f32_32x32x16_bf16 v[96:111], v[60:63], v[48:51], v[96:111]
    v_mfma_f32_32x32x16_bf16 v[128:143], v[60:63], v[52:55], v[128:143]
    s_waitcnt vmcnt(0)
    v_mfma_f32_32x32x16_bf16 v[80:95], v[72:75], v[64:67], v[80:95]
    v_mfma_f32_32x32x16_bf16 v[112:127], v[72:75], v[68:71], v[112:127]
    v_mfma_f32_32x32x16_bf16 v[96:111], v[76:79], v[64:67], v[96:111]
    v_mfma_f32_32x32x16_bf16 v[128:143], v[76:79], v[68:71], v[128:143]
    s_setprio 3
    s_nop 15
    s_mul_i32 s58, s33, 12288
    s_add_u32 s58, s58, 33792
    v_lshlrev_b32 v4, 4, v2
    v_add_u32 v5, s58, v4
    s_cmp_eq_u32 s33, 1
    s_cbranch_scc1 rs_w_27
    s_cmp_eq_u32 s33, 2
    s_cbranch_scc1 rs_w_28
    s_cmp_eq_u32 s33, 3
    s_cbranch_scc1 rs_w_29
    ds_write_b128 v5, v[96:99] offset:0
    ds_write_b128 v5, v[100:103] offset:1024
    ds_write_b128 v5, v[104:107] offset:2048
    ds_write_b128 v5, v[108:111] offset:3072
    ds_write_b128 v5, v[112:115] offset:4096
    ds_write_b128 v5, v[116:119] offset:5120
    ds_write_b128 v5, v[120:123] offset:6144
    ds_write_b128 v5, v[124:127] offset:7168
    ds_write_b128 v5, v[128:131] offset:8192
    ds_write_b128 v5, v[132:135] offset:9216
    ds_write_b128 v5, v[136:139] offset:10240
    ds_write_b128 v5, v[140:143] offset:11264
    s_waitcnt lgkmcnt(0)
    v_mov_b32 v10, 82944
    v_mov_b32 v11, 1
    s_mov_b64 s[56:57], exec
    s_mov_b64 exec, 1
    ds_add_u32 v10, v11
    s_mov_b64 exec, s[56:57]
kB_30:
    ds_read_b32 v11, v10
    s_waitcnt lgkmcnt(0)
    v_readfirstlane_b32 s56, v11
    s_nop 3
    s_cmp_lt_u32 s56, 4
    s_cbranch_scc1 kB_30
    v_add_u32 v6, 0x3000, v5
    ds_read_b128 v[96:99], v6 offset:0
    ds_read_b128 v[100:103], v6 offset:1024
    ds_read_b128 v[104:107], v6 offset:2048
    ds_read_b128 v[108:111], v6 offset:3072
    v_add_u32 v7, 0x6000, v5
    ds_read_b128 v[112:115], v7 offset:0
    ds_read_b128 v[116:119], v7 offset:1024
    ds_read_b128 v[120:123], v7 offset:2048
    ds_read_b128 v[124:127], v7 offset:3072
    v_add_u32 v8, 0x9000, v5
    ds_read_b128 v[128:131], v8 offset:0
    ds_read_b128 v[132:135], v8 offset:1024
    ds_read_b128 v[136:139], v8 offset:2048
    ds_read_b128 v[140:143], v8 offset:3072
    s_waitcnt lgkmcnt(4)
    v_pk_add_f32 v[96:97], v[96:97], v[112:113]
    v_pk_add_f32 v[98:99], v[98:99], v[114:115]
    v_pk_add_f32 v[100:101], v[100:101], v[116:117]
    v_pk_add_f32 v[102:103], v[102:103], v[118:119]
    v_pk_add_f32 v[104:105], v[104:105], v[120:121]
    v_pk_add_f32 v[106:107], v[106:107], v[122:123]
    v_pk_add_f32 v[108:109], v[108:109], v[124:125]
    v_pk_add_f32 v[110:111], v[110:111], v[126:127]
    s_waitcnt lgkmcnt(0)
    v_pk_add_f32 v[128:129], v[128:129], v[80:81]
    v_pk_add_f32 v[130:131], v[130:131], v[82:83]
    v_pk_add_f32 v[132:133], v[132:133], v[84:85]
    v_pk_add_f32 v[134:135], v[134:135], v[86:87]
    v_pk_add_f32 v[136:137], v[136:137], v[88:89]
    v_pk_add_f32 v[138:139], v[138:139], v[90:91]
    v_pk_add_f32 v[140:141], v[140:141], v[92:93]
    v_pk_add_f32 v[142:143], v[142:143], v[94:95]
    v_pk_add_f32 v[80:81], v[96:97], v[128:129]
    v_pk_add_f32 v[82:83], v[98:99], v[130:131]
    v_pk_add_f32 v[84:85], v[100:101], v[132:133]
    v_pk_add_f32 v[86:87], v[102:103], v[134:135]
    v_pk_add_f32 v[88:89], v[104:105], v[136:137]
    v_pk_add_f32 v[90:91], v[106:107], v[138:139]
    v_pk_add_f32 v[92:93], v[108:109], v[140:141]
    v_pk_add_f32 v[94:95], v[110:111], v[142:143]
    s_branch rs_end_25
rs_w_27:
    ds_write_b128 v5, v[80:83] offset:0
    ds_write_b128 v5, v[84:87] offset:1024
    ds_write_b128 v5, v[88:91] offset:2048
    ds_write_b128 v5, v[92:95] offset:3072
    ds_write_b128 v5, v[112:115] offset:4096
    ds_write_b128 v5, v[116:119] offset:5120
    ds_write_b128 v5, v[120:123] offset:6144
    ds_write_b128 v5, v[124:127] offset:7168
    ds_write_b128 v5, v[128:131] offset:8192
    ds_write_b128 v5, v[132:135] offset:9216
    ds_write_b128 v5, v[136:139] offset:10240
    ds_write_b128 v5, v[140:143] offset:11264
    s_waitcnt lgkmcnt(0)
    v_mov_b32 v10, 82944
    v_mov_b32 v11, 1
    s_mov_b64 s[56:57], exec
    s_mov_b64 exec, 1
    ds_add_u32 v10, v11
    s_mov_b64 exec, s[56:57]
kB_31:
    ds_read_b32 v11, v10
    s_waitcnt lgkmcnt(0)
    v_readfirstlane_b32 s56, v11
    s_nop 3
    s_cmp_lt_u32 s56, 4
    s_cbranch_scc1 kB_31
    v_add_u32 v6, 0xffffd000, v5
    ds_read_b128 v[80:83], v6 offset:0
    ds_read_b128 v[84:87], v6 offset:1024
    ds_read_b128 v[88:91], v6 offset:2048
    ds_read_b128 v[92:95], v6 offset:3072
    v_add_u32 v7, 0x3000, v5
    ds_read_b128 v[112:115], v7 offset:4096
    ds_read_b128 v[116:119], v7 offset:5120
    ds_read_b128 v[120:123], v7 offset:6144
    ds_read_b128 v[124:127], v7 offset:7168
    v_add_u32 v8, 0x6000, v5
    ds_read_b128 v[128:131], v8 offset:4096
    ds_read_b128 v[132:135], v8 offset:5120
    ds_read_b128 v[136:139], v8 offset:6144
    ds_read_b128 v[140:143], v8 offset:7168
    s_waitcnt lgkmcnt(4)
    v_pk_add_f32 v[80:81], v[80:81], v[112:113]
    v_pk_add_f32 v[82:83], v[82:83], v[114:115]
    v_pk_add_f32 v[84:85], v[84:85], v[116:117]
    v_pk_add_f32 v[86:87], v[86:87], v[118:119]
    v_pk_add_f32 v[88:89], v[88:89], v[120:121]
    v_pk_add_f32 v[90:91], v[90:91], v[122:123]
    v_pk_add_f32 v[92:93], v[92:93], v[124:125]
    v_pk_add_f32 v[94:95], v[94:95], v[126:127]
    s_waitcnt lgkmcnt(0)
    v_pk_add_f32 v[128:129], v[128:129], v[96:97]
    v_pk_add_f32 v[130:131], v[130:131], v[98:99]
    v_pk_add_f32 v[132:133], v[132:133], v[100:101]
    v_pk_add_f32 v[134:135], v[134:135], v[102:103]
    v_pk_add_f32 v[136:137], v[136:137], v[104:105]
    v_pk_add_f32 v[138:139], v[138:139], v[106:107]
    v_pk_add_f32 v[140:141], v[140:141], v[108:109]
    v_pk_add_f32 v[142:143], v[142:143], v[110:111]
    v_pk_add_f32 v[80:81], v[80:81], v[128:129]
    v_pk_add_f32 v[82:83], v[82:83], v[130:131]
    v_pk_add_f32 v[84:85], v[84:85], v[132:133]
    v_pk_add_f32 v[86:87], v[86:87], v[134:135]
    v_pk_add_f32 v[88:89], v[88:89], v[136:137]
    v_pk_add_f32 v[90:91], v[90:91], v[138:139]
    v_pk_add_f32 v[92:93], v[92:93], v[140:141]
    v_pk_add_f32 v[94:95], v[94:95], v[142:143]
    s_branch rs_end_25
rs_w_28:
    ds_write_b128 v5, v[80:83] offset:0
    ds_write_b128 v5, v[84:87] offset:1024
    ds_write_b128 v5, v[88:91] offset:2048
    ds_write_b128 v5, v[92:95] offset:3072
    ds_write_b128 v5, v[96:99] offset:4096
    ds_write_b128 v5, v[100:103] offset:5120
    ds_write_b128 v5, v[104:107] offset:6144
    ds_write_b128 v5, v[108:111] offset:7168
    ds_write_b128 v5, v[128:131] offset:8192
    ds_write_b128 v5, v[132:135] offset:9216
    ds_write_b128 v5, v[136:139] offset:10240
    ds_write_b128 v5, v[140:143] offset:11264
    s_waitcnt lgkmcnt(0)
    v_mov_b32 v10, 82944
    v_mov_b32 v11, 1
    s_mov_b64 s[56:57], exec
    s_mov_b64 exec, 1
    ds_add_u32 v10, v11
    s_mov_b64 exec, s[56:57]
kB_32:
    ds_read_b32 v11, v10
    s_waitcnt lgkmcnt(0)
    v_readfirstlane_b32 s56, v11
    s_nop 3
    s_cmp_lt_u32 s56, 4
    s_cbranch_scc1 kB_32
    v_add_u32 v6, 0xffffa000, v5
    ds_read_b128 v[80:83], v6 offset:4096
    ds_read_b128 v[84:87], v6 offset:5120
    ds_read_b128 v[88:91], v6 offset:6144
    ds_read_b128 v[92:95], v6 offset:7168
    v_add_u32 v7, 0xffffd000, v5
    ds_read_b128 v[96:99], v7 offset:4096
    ds_read_b128 v[100:103], v7 offset:5120
    ds_read_b128 v[104:107], v7 offset:6144
    ds_read_b128 v[108:111], v7 offset:7168
    v_add_u32 v8, 0x3000, v5
    ds_read_b128 v[128:131], v8 offset:8192
    ds_read_b128 v[132:135], v8 offset:9216
    ds_read_b128 v[136:139], v8 offset:10240
    ds_read_b128 v[140:143], v8 offset:11264
    s_waitcnt lgkmcnt(4)
    v_pk_add_f32 v[80:81], v[80:81], v[96:97]
    v_pk_add_f32 v[82:83], v[82:83], v[98:99]
    v_pk_add_f32 v[84:85], v[84:85], v[100:101]
    v_pk_add_f32 v[86:87], v[86:87], v[102:103]
    v_pk_add_f32 v[88:89], v[88:89], v[104:105]
    v_pk_add_f32 v[90:91], v[90:91], v[106:107]
    v_pk_add_f32 v[92:93], v[92:93], v[108:109]
    v_pk_add_f32 v[94:95], v[94:95], v[110:111]
    s_waitcnt lgkmcnt(0)
    v_pk_add_f32 v[128:129], v[128:129], v[112:113]
    v_pk_add_f32 v[130:131], v[130:131], v[114:115]
    v_pk_add_f32 v[132:133], v[132:133], v[116:117]
    v_pk_add_f32 v[134:135], v[134:135], v[118:119]
    v_pk_add_f32 v[136:137], v[136:137], v[120:121]
    v_pk_add_f32 v[138:139], v[138:139], v[122:123]
    v_pk_add_f32 v[140:141], v[140:141], v[124:125]
    v_pk_add_f32 v[142:143], v[142:143], v[126:127]
    v_pk_add_f32 v[80:81], v[80:81], v[128:129]
    v_pk_add_f32 v[82:83], v[82:83], v[130:131]
    v_pk_add_f32 v[84:85], v[84:85], v[132:133]
    v_pk_add_f32 v[86:87], v[86:87], v[134:135]
    v_pk_add_f32 v[88:89], v[88:89], v[136:137]
    v_pk_add_f32 v[90:91], v[90:91], v[138:139]
    v_pk_add_f32 v[92:93], v[92:93], v[140:141]
    v_pk_add_f32 v[94:95], v[94:95], v[142:143]
    s_branch rs_end_25
rs_w_29:
    ds_write_b128 v5, v[80:83] offset:0
    ds_write_b128 v5, v[84:87] offset:1024
    ds_write_b128 v5, v[88:91] offset:2048
    ds_write_b128 v5, v[92:95] offset:3072
    ds_write_b128 v5, v[96:99] offset:4096
    ds_write_b128 v5, v[100:103] offset:5120
    ds_write_b128 v5, v[104:107] offset:6144
    ds_write_b128 v5, v[108:111] offset:7168
    ds_write_b128 v5, v[112:115] offset:8192
    ds_write_b128 v5, v[116:119] offset:9216
    ds_write_b128 v5, v[120:123] offset:10240
    ds_write_b128 v5, v[124:127] offset:11264
    s_waitcnt lgkmcnt(0)
    v_mov_b32 v10, 82944
    v_mov_b32 v11, 1
    s_mov_b64 s[56:57], exec
    s_mov_b64 exec, 1
    ds_add_u32 v10, v11
    s_mov_b64 exec, s[56:57]
kB_33:
    ds_read_b32 v11, v10
    s_waitcnt lgkmcnt(0)
    v_readfirstlane_b32 s56, v11
    s_nop 3
    s_cmp_lt_u32 s56, 4
    s_cbranch_scc1 kB_33
    v_add_u32 v6, 0xffff7000, v5
    ds_read_b128 v[80:83], v6 offset:8192
    ds_read_b128 v[84:87], v6 offset:9216
    ds_read_b128 v[88:91], v6 offset:10240
    ds_read_b128 v[92:95], v6 offset:11264
    v_add_u32 v7, 0xffffa000, v5
    ds_read_b128 v[96:99], v7 offset:8192
    ds_read_b128 v[100:103], v7 offset:9216
    ds_read_b128 v[104:107], v7 offset:10240
    ds_read_b128 v[108:111], v7 offset:11264
    v_add_u32 v8, 0xffffd000, v5
    ds_read_b128 v[112:115], v8 offset:8192
    ds_read_b128 v[116:119], v8 offset:9216
    ds_read_b128 v[120:123], v8 offset:10240
    ds_read_b128 v[124:127], v8 offset:11264
    s_waitcnt lgkmcnt(4)
    v_pk_add_f32 v[80:81], v[80:81], v[96:97]
    v_pk_add_f32 v[82:83], v[82:83], v[98:99]
    v_pk_add_f32 v[84:85], v[84:85], v[100:101]
    v_pk_add_f32 v[86:87], v[86:87], v[102:103]
    v_pk_add_f32 v[88:89], v[88:89], v[104:105]
    v_pk_add_f32 v[90:91], v[90:91], v[106:107]
    v_pk_add_f32 v[92:93], v[92:93], v[108:109]
    v_pk_add_f32 v[94:95], v[94:95], v[110:111]
    s_waitcnt lgkmcnt(0)
    v_pk_add_f32 v[112:113], v[112:113], v[128:129]
    v_pk_add_f32 v[114:115], v[114:115], v[130:131]
    v_pk_add_f32 v[116:117], v[116:117], v[132:133]
    v_pk_add_f32 v[118:119], v[118:119], v[134:135]
    v_pk_add_f32 v[120:121], v[120:121], v[136:137]
    v_pk_add_f32 v[122:123], v[122:123], v[138:139]
    v_pk_add_f32 v[124:125], v[124:125], v[140:141]
    v_pk_add_f32 v[126:127], v[126:127], v[142:143]
    v_pk_add_f32 v[80:81], v[80:81], v[112:113]
    v_pk_add_f32 v[82:83], v[82:83], v[114:115]
    v_pk_add_f32 v[84:85], v[84:85], v[116:117]
    v_pk_add_f32 v[86:87], v[86:87], v[118:119]
    v_pk_add_f32 v[88:89], v[88:89], v[120:121]
    v_pk_add_f32 v[90:91], v[90:91], v[122:123]
    v_pk_add_f32 v[92:93], v[92:93], v[124:125]
    v_pk_add_f32 v[94:95], v[94:95], v[126:127]
rs_end_25:
    s_waitcnt vmcnt(0)
    v_mul_f32_e64 v154, -v152, v153
    v_mov_b32 v155, v154
    v_mov_b32 v152, v153
    v_lshlrev_b32 v16, 16, v144
    v_and_b32 v17, 0xffff0000, v144
    v_pk_fma_f32 v[80:81], v[16:17], v[152:153], v[80:81]
    v_pk_add_f32 v[80:81], v[80:81], v[154:155]
    v_lshlrev_b32 v16, 16, v145
    v_and_b32 v17, 0xffff0000, v145
    v_pk_fma_f32 v[82:83], v[16:17], v[152:153], v[82:83]
    v_pk_add_f32 v[82:83], v[82:83], v[154:155]
    v_lshlrev_b32 v16, 16, v146
    v_and_b32 v17, 0xffff0000, v146
    v_pk_fma_f32 v[84:85], v[16:17], v[152:153], v[84:85]
    v_pk_add_f32 v[84:85], v[84:85], v[154:155]
    v_lshlrev_b32 v16, 16, v147
    v_and_b32 v17, 0xffff0000, v147
    v_pk_fma_f32 v[86:87], v[16:17], v[152:153], v[86:87]
    v_pk_add_f32 v[86:87], v[86:87], v[154:155]
    v_lshlrev_b32 v16, 16, v148
    v_and_b32 v17, 0xffff0000, v148
    v_pk_fma_f32 v[88:89], v[16:17], v[152:153], v[88:89]
    v_pk_add_f32 v[88:89], v[88:89], v[154:155]
    v_lshlrev_b32 v16, 16, v149
    v_and_b32 v17, 0xffff0000, v149
    v_pk_fma_f32 v[90:91], v[16:17], v[152:153], v[90:91]
    v_pk_add_f32 v[90:91], v[90:91], v[154:155]
    v_lshlrev_b32 v16, 16, v150
    v_and_b32 v17, 0xffff0000, v150
    v_pk_fma_f32 v[92:93], v[16:17], v[152:153], v[92:93]
    v_pk_add_f32 v[92:93], v[92:93], v[154:155]
    v_lshlrev_b32 v16, 16, v151
    v_and_b32 v17, 0xffff0000, v151
    v_pk_fma_f32 v[94:95], v[16:17], v[152:153], v[94:95]
    v_pk_add_f32 v[94:95], v[94:95], v[154:155]
    v_pk_add_f32 v[18:19], v[80:81], v[82:83]
    v_pk_mul_f32 v[20:21], v[80:81], v[80:81]
    v_pk_fma_f32 v[20:21], v[82:83], v[82:83], v[20:21]
    v_pk_add_f32 v[18:19], v[18:19], v[84:85]
    v_pk_fma_f32 v[20:21], v[84:85], v[84:85], v[20:21]
    v_pk_add_f32 v[18:19], v[18:19], v[86:87]
    v_pk_fma_f32 v[20:21], v[86:87], v[86:87], v[20:21]
    v_pk_add_f32 v[18:19], v[18:19], v[88:89]
    v_pk_fma_f32 v[20:21], v[88:89], v[88:89], v[20:21]
    v_pk_add_f32 v[18:19], v[18:19], v[90:91]
    v_pk_fma_f32 v[20:21], v[90:91], v[90:91], v[20:21]
    v_pk_add_f32 v[18:19], v[18:19], v[92:93]
    v_pk_fma_f32 v[20:21], v[92:93], v[92:93], v[20:21]
    v_pk_add_f32 v[18:19], v[18:19], v[94:95]
    v_pk_fma_f32 v[20:21], v[94:95], v[94:95], v[20:21]
    v_add_f32 v18, v18, v19
    v_add_f32 v19, v20, v21
    v_mov_b32 v20, v18
    v_mov_b32 v21, v19
    s_nop 1
    v_permlane32_swap_b32 v18, v20
    v_permlane32_swap_b32 v19, v21
    s_nop 1
    v_add_f32 v18, v18, v20
    v_add_f32 v19, v19, v21
    v_cvt_pk_bf16_f32 v24, v80, v81
    v_cvt_pk_bf16_f32 v25, v82, v83
    v_cvt_pk_bf16_f32 v26, v84, v85
    v_cvt_pk_bf16_f32 v27, v86, v87
    v_cvt_pk_bf16_f32 v28, v88, v89
    v_cvt_pk_bf16_f32 v29, v90, v91
    v_cvt_pk_bf16_f32 v30, v92, v93
    v_cvt_pk_bf16_f32 v31, v94, v95
    s_lshl_b32 s44, s26, 1
    s_add_u32 s44, s44, s40
    s_lshl_b32 s44, s44, 5
    s_lshl_b32 s45, s27, 2
    s_add_u32 s44, s44, s45
    s_lshl_b32 s45, s41, 1
    s_add_u32 s44, s44, s45
    s_lshl_b32 s44, s44, 10
    s_add_u32 s44, s44, 0x800000
    v_lshlrev_b32 v22, 4, v2
    buffer_store_dwordx4 v[24:27], v22, s[28:31], s44 offen
    buffer_store_dwordx4 v[28:31], v22, s[28:31], s44 offen offset:1024
    s_lshl_b32 s44, s42, 7
    s_lshl_b32 s45, s27, 1
    s_add_u32 s45, s45, s41
    s_lshl_b32 s45, s45, 3
    s_add_u32 s44, s44, s45
    s_add_u32 s44, s44, 0x1480000
    v_lshlrev_b32 v23, 7, v12
    s_mov_b32 exec_hi, 0
    buffer_store_dwordx2 v[18:19], v23, s[28:31], s44 offen
    s_endpgm
kB_attn:
    s_lshr_b32 s26, s25, 2
    s_sub_u32 s26, 7, s26
    s_and_b32 s27, s25, 3
    s_lshl_b32 s28, s24, 2
    s_add_u32 s27, s27, s28
    s_lshl_b32 s34, s26, 3
    s_add_u32 s35, s34, s33
    s_waitcnt lgkmcnt(0)
    s_lshl_b32 s36, s27, 16
    s_add_u32 s8, s22, s36
    s_addc_u32 s9, s23, 0
    s_add_u32 s8, s8, 0x200000
    s_addc_u32 s9, s9, 0
    s_mov_b32 s10, 0x10000
    s_mov_b32 s11, 0x20000
    s_add_u32 s12, s22, s36
    s_addc_u32 s13, s23, 0
    s_add_u32 s12, s12, 0x400000
    s_addc_u32 s13, s13, 0
    s_mov_b32 s14, 0x10000
    s_mov_b32 s15, 0x20000
    s_mov_b32 s28, s22
    s_mov_b32 s29, s23
    s_mov_b32 s30, 0x10000000
    s_mov_b32 s31, 0x20000
    v_lshlrev_b32 v3, 4, v2
    s_lshl_b32 s37, s33, 1
    s_add_u32 s38, s34, s37
    s_sub_u32 s38, s38, 8
    s_lshl_b32 s38, s38, 10
    s_lshl_b32 s37, s37, 10
    s_mov_b32 s39, 0
    s_add_u32 s40, s38, 0
    v_add_u32 v4, s40, v3
    s_add_u32 m0, s37, 0
    s_nop 0
    buffer_load_dwordx4 v4, s[8:11], s39 offen lds
    s_add_u32 m0, s37, 16384
    s_nop 0
    buffer_load_dwordx4 v4, s[12:15], s39 offen lds
    s_add_u32 s40, s38, 1024
    v_add_u32 v4, s40, v3
    s_add_u32 m0, s37, 1024
    s_nop 0
    buffer_load_dwordx4 v4, s[8:11], s39 offen lds
    s_add_u32 m0, s37, 17408
    s_nop 0
    buffer_load_dwordx4 v4, s[12:15], s39 offen lds
    s_lshl_b32 s40, s35, 10
    s_add_u32 s40, s40, s36
    s_add_u32 s40, s40, 0x0
    buffer_load_dwordx4 v[8:11], v3, s[28:31], s40 offen
    v_mov_b32 v5, 0x3f803f80
    v_and_b32 v6, 255, v0
    v_lshlrev_b32 v6, 2, v6
    ds_write_b32 v6, v5 offset:32768
    v_lshrrev_b32 v13, 5, v2
    v_lshlrev_b32 v14, 7, v13
    v_bfe_u32 v15, v2, 1, 1
    v_lshl_add_u32 v14, v15, 6, v14
    v_bfe_u32 v15, v2, 2, 2
    v_lshl_add_u32 v14, v15, 4, v14
    v_and_b32 v15, 1, v2
    v_lshl_add_u32 v14, v15, 3, v14
    v_add_u32 v14, 16384, v14
    v_lshlrev_b32 v13, 7, v13
    v_xor_b32 v13, 128, v13
    v_add_u32 v13, 32768, v13
    v_bfe_u32 v15, v2, 4, 1
    v_cmp_eq_u32 s[44:45], 0, v15
    v_mov_b32 v15, 1024
    v_cndmask_b32 v12, 0, v15, s[44:45]
    s_cmp_ge_u32 s26, 1
    s_cselect_b32 s46, s33, 8
    s_lshl_b32 s46, s46, 10
    v_add_u32 v14, s46, v14
    v_cndmask_b32 v7, v13, v14, s[44:45]
    v_add_u32 v6, s46, v3
    v_and_b32 v13, 31, v2
    v_lshrrev_b32 v14, 5, v2
    v_lshlrev_b32 v14, 2, v14
    v_sub_u32 v13, v13, v14
    v_mov_b32 v14, 0xf149f2ca
    v_cmp_gt_i32 s[48:49], 0, v13
    v_cmp_gt_i32 s[50:51], 1, v13
    v_cmp_gt_i32 s[52:53], 2, v13
    v_cmp_gt_i32 s[54:55], 3, v13
    v_cmp_gt_i32 s[56:57], 8, v13
    v_cmp_gt_i32 s[58:59], 9, v13
    v_cmp_gt_i32 s[60:61], 10, v13
    v_cmp_gt_i32 s[62:63], 11, v13
    v_cndmask_b32 v64, v14, 0, s[48:49]
    v_cndmask_b32 v80, 0, v14, s[48:49]
    v_cndmask_b32 v65, v14, 0, s[50:51]
    v_cndmask_b32 v81, 0, v14, s[50:51]
    v_cndmask_b32 v66, v14, 0, s[52:53]
    v_cndmask_b32 v82, 0, v14, s[52:53]
    v_cndmask_b32 v67, v14, 0, s[54:55]
    v_cndmask_b32 v83, 0, v14, s[54:55]
    v_cndmask_b32 v68, v14, 0, s[56:57]
    v_cndmask_b32 v84, 0, v14, s[56:57]
    v_cndmask_b32 v69, v14, 0, s[58:59]
    v_cndmask_b32 v85, 0, v14, s[58:59]
    v_cndmask_b32 v70, v14, 0, s[60:61]
    v_cndmask_b32 v86, 0, v14, s[60:61]
    v_cndmask_b32 v71, v14, 0, s[62:63]
    v_cndmask_b32 v87, 0, v14, s[62:63]
    v_cmp_gt_i32 s[48:49], 16, v13
    v_cmp_gt_i32 s[50:51], 17, v13
    v_cmp_gt_i32 s[52:53], 18, v13
    v_cmp_gt_i32 s[54:55], 19, v13
    v_cmp_gt_i32 s[56:57], 24, v13
    v_cmp_gt_i32 s[58:59], 25, v13
    v_cmp_gt_i32 s[60:61], 26, v13
    v_cmp_gt_i32 s[62:63], 27, v13
    v_cndmask_b32 v72, v14, 0, s[48:49]
    v_cndmask_b32 v88, 0, v14, s[48:49]
    v_cndmask_b32 v73, v14, 0, s[50:51]
    v_cndmask_b32 v89, 0, v14, s[50:51]
    v_cndmask_b32 v74, v14, 0, s[52:53]
    v_cndmask_b32 v90, 0, v14, s[52:53]
    v_cndmask_b32 v75, v14, 0, s[54:55]
    v_cndmask_b32 v91, 0, v14, s[54:55]
    v_cndmask_b32 v76, v14, 0, s[56:57]
    v_cndmask_b32 v92, 0, v14, s[56:57]
    v_cndmask_b32 v77, v14, 0, s[58:59]
    v_cndmask_b32 v93, 0, v14, s[58:59]
    v_cndmask_b32 v78, v14, 0, s[60:61]
    v_cndmask_b32 v94, 0, v14, s[60:61]
    v_cndmask_b32 v79, v14, 0, s[62:63]
    v_cndmask_b32 v95, 0, v14, s[62:63]
    s_waitcnt vmcnt(0) lgkmcnt(0)
    s_barrier
    s_cmp_lt_u32 s26, 1
    s_cbranch_scc1 kB_slow
    ds_read_b128 v[16:19], v6 offset:0
    ds_read_b128 v[20:23], v6 offset:1024
    s_waitcnt lgkmcnt(1)
    v_mfma_f32_32x32x16_bf16 v[32:47], v[16:19], v[8:11], v[64:79]
    s_waitcnt lgkmcnt(0)
    v_mfma_f32_32x32x16_bf16 v[48:63], v[20:23], v[8:11], 0
    ds_read_b128 v[16:19], v6 offset:2048
    s_nop 8
    v_max_f32 v24, v32, v33
    v_max3_f32 v24, v34, v35, v24
    v_max3_f32 v24, v36, v37, v24
    v_max3_f32 v24, v38, v39, v24
    v_max3_f32 v24, v40, v41, v24
    v_max3_f32 v24, v42, v43, v24
    v_max3_f32 v24, v44, v45, v24
    v_max3_f32 v24, v46, v47, v24
    s_waitcnt lgkmcnt(0)
    v_mfma_f32_32x32x16_bf16 v[32:47], v[16:19], v[8:11], 0
    ds_read_b128 v[20:23], v6 offset:3072
    v_max3_f32 v24, v48, v49, v24
    v_max3_f32 v24, v50, v51, v24
    v_max3_f32 v24, v52, v53, v24
    v_max3_f32 v24, v54, v55, v24
    v_max3_f32 v24, v56, v57, v24
    v_max3_f32 v24, v58, v59, v24
    v_max3_f32 v24, v60, v61, v24
    v_max3_f32 v24, v62, v63, v24
    s_waitcnt lgkmcnt(0)
    v_mfma_f32_32x32x16_bf16 v[48:63], v[20:23], v[8:11], 0
    ds_read_b128 v[16:19], v6 offset:4096
    v_max3_f32 v24, v32, v33, v24
    v_max3_f32 v24, v34, v35, v24
    v_max3_f32 v24, v36, v37, v24
    v_max3_f32 v24, v38, v39, v24
    v_max3_f32 v24, v40, v41, v24
    v_max3_f32 v24, v42, v43, v24
    v_max3_f32 v24, v44, v45, v24
    v_max3_f32 v24, v46, v47, v24
    s_waitcnt lgkmcnt(0)
    v_mfma_f32_32x32x16_bf16 v[32:47], v[16:19], v[8:11], 0
    ds_read_b128 v[20:23], v6 offset:5120
    v_max3_f32 v24, v48, v49, v24
    v_max3_f32 v24, v50, v51, v24
    v_max3_f32 v24, v52, v53, v24
    v_max3_f32 v24, v54, v55, v24
    v_max3_f32 v24, v56, v57, v24
    v_max3_f32 v24, v58, v59, v24
    v_max3_f32 v24, v60, v61, v24
    v_max3_f32 v24, v62, v63, v24
    s_waitcnt lgkmcnt(0)
    v_mfma_f32_32x32x16_bf16 v[48:63], v[20:23], v[8:11], 0
    ds_read_b128 v[16:19], v6 offset:6144
    v_max3_f32 v24, v32, v33, v24
    v_max3_f32 v24, v34, v35, v24
    v_max3_f32 v24, v36, v37, v24
    v_max3_f32 v24, v38, v39, v24
    v_max3_f32 v24, v40, v41, v24
    v_max3_f32 v24, v42, v43, v24
    v_max3_f32 v24, v44, v45, v24
    v_max3_f32 v24, v46, v47, v24
    s_waitcnt lgkmcnt(0)
    v_mfma_f32_32x32x16_bf16 v[32:47], v[16:19], v[8:11], 0
    ds_read_b128 v[20:23], v6 offset:7168
    v_max3_f32 v24, v48, v49, v24
    v_max3_f32 v24, v50, v51, v24
    v_max3_f32 v24, v52, v53, v24
    v_max3_f32 v24, v54, v55, v24
    v_max3_f32 v24, v56, v57, v24
    v_max3_f32 v24, v58, v59, v24
    v_max3_f32 v24, v60, v61, v24
    v_max3_f32 v24, v62, v63, v24
    s_waitcnt lgkmcnt(0)
    v_mfma_f32_32x32x16_bf16 v[48:63], v[20:23], v[8:11], 0
    ds_read_b128 v[16:19], v6 offset:8192
    v_max3_f32 v24, v32, v33, v24
    v_max3_f32 v24, v34, v35, v24
    v_max3_f32 v24, v36, v37, v24
    v_max3_f32 v24, v38, v39, v24
    v_max3_f32 v24, v40, v41, v24
    v_max3_f32 v24, v42, v43, v24
    v_max3_f32 v24, v44, v45, v24
    v_max3_f32 v24, v46, v47, v24
    s_waitcnt lgkmcnt(0)
    v_mfma_f32_32x32x16_bf16 v[32:47], v[16:19], v[8:11], v[80:95]
    s_nop 0
    v_max3_f32 v24, v48, v49, v24
    v_max3_f32 v24, v50, v51, v24
    v_max3_f32 v24, v52, v53, v24
    v_max3_f32 v24, v54, v55, v24
    v_max3_f32 v24, v56, v57, v24
    v_max3_f32 v24, v58, v59, v24
    v_max3_f32 v24, v60, v61, v24
    v_max3_f32 v24, v62, v63, v24
    s_nop 2
    v_max3_f32 v24, v32, v33, v24
    v_max3_f32 v24, v34, v35, v24
    v_max3_f32 v24, v36, v37, v24
    v_max3_f32 v24, v38, v39, v24
    v_max3_f32 v24, v40, v41, v24
    v_max3_f32 v24, v42, v43, v24
    v_max3_f32 v24, v44, v45, v24
    v_max3_f32 v24, v46, v47, v24
    v_mov_b32 v25, v24
    s_nop 1
    v_permlane32_swap_b32 v24, v25
    s_nop 1
    v_max_f32 v24, v24, v25
    v_sub_f32 v96, 0, v24
    v_mov_b32 v97, v96
    v_mov_b32 v98, v96
    v_mov_b32 v99, v96
    v_mov_b32 v100, v96
    v_mov_b32 v101, v96
    v_mov_b32 v102, v96
    v_mov_b32 v103, v96
    v_mov_b32 v104, v96
    v_mov_b32 v105, v96
    v_mov_b32 v106, v96
    v_mov_b32 v107, v96
    v_mov_b32 v108, v96
    v_mov_b32 v109, v96
    v_mov_b32 v110, v96
    v_mov_b32 v111, v96
    v_sub_f32 v64, v64, v24
    v_sub_f32 v80, v80, v24
    v_sub_f32 v65, v65, v24
    v_sub_f32 v81, v81, v24
    v_sub_f32 v66, v66, v24
    v_sub_f32 v82, v82, v24
    v_sub_f32 v67, v67, v24
    v_sub_f32 v83, v83, v24
    v_sub_f32 v68, v68, v24
    v_sub_f32 v84, v84, v24
    v_sub_f32 v69, v69, v24
    v_sub_f32 v85, v85, v24
    v_sub_f32 v70, v70, v24
    v_sub_f32 v86, v86, v24
    v_sub_f32 v71, v71, v24
    v_sub_f32 v87, v87, v24
    v_sub_f32 v72, v72, v24
    v_sub_f32 v88, v88, v24
    v_sub_f32 v73, v73, v24
    v_sub_f32 v89, v89, v24
    v_sub_f32 v74, v74, v24
    v_sub_f32 v90, v90, v24
    v_sub_f32 v75, v75, v24
    v_sub_f32 v91, v91, v24
    v_sub_f32 v76, v76, v24
    v_sub_f32 v92, v92, v24
    v_sub_f32 v77, v77, v24
    v_sub_f32 v93, v93, v24
    v_sub_f32 v78, v78, v24
    v_sub_f32 v94, v94, v24
    v_sub_f32 v79, v79, v24
    v_sub_f32 v95, v95, v24
    ds_read_b128 v[16:19], v6 offset:0
    ds_read_b128 v[20:23], v6 offset:1024
    ds_read_b64_tr_b16 v[120:121], v7 offset:0
    ds_read_b64_tr_b16 v[122:123], v7 offset:256
    ds_read_b64_tr_b16 v[124:125], v7 offset:512
    ds_read_b64_tr_b16 v[126:127], v7 offset:768
    s_waitcnt lgkmcnt(5)
    v_mfma_f32_32x32x16_bf16 v[32:47], v[16:19], v[8:11], v[64:79]
    s_waitcnt lgkmcnt(4)
    v_mfma_f32_32x32x16_bf16 v[48:63], v[20:23], v[8:11], v[96:111]
    ds_read_b128 v[16:19], v6 offset:2048
    v_add_u32 v7, v7, v12
    ds_read_b64_tr_b16 v[128:129], v7 offset:0
    ds_read_b64_tr_b16 v[130:131], v7 offset:256
    ds_read_b64_tr_b16 v[132:133], v7 offset:512
    ds_read_b64_tr_b16 v[134:135], v7 offset:768
    s_nop 3
    v_exp_f32 v32, v32
    v_exp_f32 v33, v33
    v_exp_f32 v34, v34
    v_exp_f32 v35, v35
    v_exp_f32 v36, v36
    v_exp_f32 v37, v37
    v_exp_f32 v38, v38
    v_exp_f32 v39, v39
    v_cvt_pk_bf16_f32 v112, v32, v33
    v_cvt_pk_bf16_f32 v113, v34, v35
    v_exp_f32 v40, v40
    v_exp_f32 v41, v41
    v_exp_f32 v42, v42
    v_exp_f32 v43, v43
    v_cvt_pk_bf16_f32 v114, v36, v37
    v_cvt_pk_bf16_f32 v115, v38, v39
    v_exp_f32 v44, v44
    v_exp_f32 v45, v45
    v_exp_f32 v46, v46
    v_exp_f32 v47, v47
    s_nop 0
    v_cvt_pk_bf16_f32 v116, v40, v41
    v_cvt_pk_bf16_f32 v117, v42, v43
    v_cvt_pk_bf16_f32 v118, v44, v45
    v_cvt_pk_bf16_f32 v119, v46, v47
    s_waitcnt lgkmcnt(5)
    s_nop 1
    v_mfma_f32_32x32x16_bf16 v[136:151], v[120:123], v[112:115], 0
    v_mfma_f32_32x32x16_bf16 v[136:151], v[124:127], v[116:119], v[136:151]
    s_waitcnt lgkmcnt(4)
    v_mfma_f32_32x32x16_bf16 v[32:47], v[16:19], v[8:11], v[96:111]
    ds_read_b128 v[20:23], v6 offset:3072
    v_add_u32 v7, v7, v12
    ds_read_b64_tr_b16 v[120:121], v7 offset:0
    ds_read_b64_tr_b16 v[122:123], v7 offset:256
    ds_read_b64_tr_b16 v[124:125], v7 offset:512
    ds_read_b64_tr_b16 v[126:127], v7 offset:768
    v_exp_f32 v48, v48
    v_exp_f32 v49, v49
    v_exp_f32 v50, v50
    v_exp_f32 v51, v51
    v_exp_f32 v52, v52
    v_exp_f32 v53, v53
    v_exp_f32 v54, v54
    v_exp_f32 v55, v55
    v_cvt_pk_bf16_f32 v112, v48, v49
    v_cvt_pk_bf16_f32 v113, v50, v51
    v_exp_f32 v56, v56
    v_exp_f32 v57, v57
    v_exp_f32 v58, v58
    v_exp_f32 v59, v59
    v_cvt_pk_bf16_f32 v114, v52, v53
    v_cvt_pk_bf16_f32 v115, v54, v55
    v_exp_f32 v60, v60
    v_exp_f32 v61, v61
    v_exp_f32 v62, v62
    v_exp_f32 v63, v63
    s_nop 0
    v_cvt_pk_bf16_f32 v116, v56, v57
    v_cvt_pk_bf16_f32 v117, v58, v59
    v_cvt_pk_bf16_f32 v118, v60, v61
    v_cvt_pk_bf16_f32 v119, v62, v63
    s_waitcnt lgkmcnt(5)
    s_nop 1
    v_mfma_f32_32x32x16_bf16 v[136:151], v[128:131], v[112:115], v[136:151]
    v_mfma_f32_32x32x16_bf16 v[136:151], v[132:135], v[116:119], v[136:151]
    s_waitcnt lgkmcnt(4)
    v_mfma_f32_32x32x16_bf16 v[48:63], v[20:23], v[8:11], v[96:111]
    ds_read_b128 v[16:19], v6 offset:4096
    v_add_u32 v7, v7, v12
    ds_read_b64_tr_b16 v[128:129], v7 offset:0
    ds_read_b64_tr_b16 v[130:131], v7 offset:256
    ds_read_b64_tr_b16 v[132:133], v7 offset:512
    ds_read_b64_tr_b16 v[134:135], v7 offset:768
    v_exp_f32 v32, v32
    v_exp_f32 v33, v33
    v_exp_f32 v34, v34
    v_exp_f32 v35, v35
    v_exp_f32 v36, v36
    v_exp_f32 v37, v37
    v_exp_f32 v38, v38
    v_exp_f32 v39, v39
    v_cvt_pk_bf16_f32 v112, v32, v33
    v_cvt_pk_bf16_f32 v113, v34, v35
    v_exp_f32 v40, v40
    v_exp_f32 v41, v41
    v_exp_f32 v42, v42
    v_exp_f32 v43, v43
    v_cvt_pk_bf16_f32 v114, v36, v37
    v_cvt_pk_bf16_f32 v115, v38, v39
    v_exp_f32 v44, v44
    v_exp_f32 v45, v45
    v_exp_f32 v46, v46
    v_exp_f32 v47, v47
    s_nop 0
    v_cvt_pk_bf16_f32 v116, v40, v41
    v_cvt_pk_bf16_f32 v117, v42, v43
    v_cvt_pk_bf16_f32 v118, v44, v45
    v_cvt_pk_bf16_f32 v119, v46, v47
    s_waitcnt lgkmcnt(5)
    s_nop 1
    v_mfma_f32_32x32x16_bf16 v[136:151], v[120:123], v[112:115], v[136:151]
    v_mfma_f32_32x32x16_bf16 v[136:151], v[124:127], v[116:119], v[136:151]
    s_waitcnt lgkmcnt(4)
    v_mfma_f32_32x32x16_bf16 v[32:47], v[16:19], v[8:11], v[96:111]
    ds_read_b128 v[20:23], v6 offset:5120
    v_add_u32 v7, v7, v12
    ds_read_b64_tr_b16 v[120:121], v7 offset:0
    ds_read_b64_tr_b16 v[122:123], v7 offset:256
    ds_read_b64_tr_b16 v[124:125], v7 offset:512
    ds_read_b64_tr_b16 v[126:127], v7 offset:768
    v_exp_f32 v48, v48
    v_exp_f32 v49, v49
    v_exp_f32 v50, v50
    v_exp_f32 v51, v51
    v_exp_f32 v52, v52
    v_exp_f32 v53, v53
    v_exp_f32 v54, v54
    v_exp_f32 v55, v55
    v_cvt_pk_bf16_f32 v112, v48, v49
    v_cvt_pk_bf16_f32 v113, v50, v51
    v_exp_f32 v56, v56
    v_exp_f32 v57, v57
    v_exp_f32 v58, v58
    v_exp_f32 v59, v59
    v_cvt_pk_bf16_f32 v114, v52, v53
    v_cvt_pk_bf16_f32 v115, v54, v55
    v_exp_f32 v60, v60
    v_exp_f32 v61, v61
    v_exp_f32 v62, v62
    v_exp_f32 v63, v63
    s_nop 0
    v_cvt_pk_bf16_f32 v116, v56, v57
    v_cvt_pk_bf16_f32 v117, v58, v59
    v_cvt_pk_bf16_f32 v118, v60, v61
    v_cvt_pk_bf16_f32 v119, v62, v63
    s_waitcnt lgkmcnt(5)
    s_nop 1
    v_mfma_f32_32x32x16_bf16 v[136:151], v[128:131], v[112:115], v[136:151]
    v_mfma_f32_32x32x16_bf16 v[136:151], v[132:135], v[116:119], v[136:151]
    s_waitcnt lgkmcnt(4)
    v_mfma_f32_32x32x16_bf16 v[48:63], v[20:23], v[8:11], v[96:111]
    ds_read_b128 v[16:19], v6 offset:6144
    v_add_u32 v7, v7, v12
    ds_read_b64_tr_b16 v[128:129], v7 offset:0
    ds_read_b64_tr_b16 v[130:131], v7 offset:256
    ds_read_b64_tr_b16 v[132:133], v7 offset:512
    ds_read_b64_tr_b16 v[134:135], v7 offset:768
    v_exp_f32 v32, v32
    v_exp_f32 v33, v33
    v_exp_f32 v34, v34
    v_exp_f32 v35, v35
    v_exp_f32 v36, v36
    v_exp_f32 v37, v37
    v_exp_f32 v38, v38
    v_exp_f32 v39, v39
    v_cvt_pk_bf16_f32 v112, v32, v33
    v_cvt_pk_bf16_f32 v113, v34, v35
    v_exp_f32 v40, v40
    v_exp_f32 v41, v41
    v_exp_f32 v42, v42
    v_exp_f32 v43, v43
    v_cvt_pk_bf16_f32 v114, v36, v37
    v_cvt_pk_bf16_f32 v115, v38, v39
    v_exp_f32 v44, v44
    v_exp_f32 v45, v45
    v_exp_f32 v46, v46
    v_exp_f32 v47, v47
    s_nop 0
    v_cvt_pk_bf16_f32 v116, v40, v41
    v_cvt_pk_bf16_f32 v117, v42, v43
    v_cvt_pk_bf16_f32 v118, v44, v45
    v_cvt_pk_bf16_f32 v119, v46, v47
    s_waitcnt lgkmcnt(5)
    s_nop 1
    v_mfma_f32_32x32x16_bf16 v[136:151], v[120:123], v[112:115], v[136:151]
    v_mfma_f32_32x32x16_bf16 v[136:151], v[124:127], v[116:119], v[136:151]
    s_waitcnt lgkmcnt(4)
    v_mfma_f32_32x32x16_bf16 v[32:47], v[16:19], v[8:11], v[96:111]
    ds_read_b128 v[20:23], v6 offset:7168
    v_add_u32 v7, v7, v12
    ds_read_b64_tr_b16 v[120:121], v7 offset:0
    ds_read_b64_tr_b16 v[122:123], v7 offset:256
    ds_read_b64_tr_b16 v[124:125], v7 offset:512
    ds_read_b64_tr_b16 v[126:127], v7 offset:768
    v_exp_f32 v48, v48
    v_exp_f32 v49, v49
    v_exp_f32 v50, v50
    v_exp_f32 v51, v51
    v_exp_f32 v52, v52
    v_exp_f32 v53, v53
    v_exp_f32 v54, v54
    v_exp_f32 v55, v55
    v_cvt_pk_bf16_f32 v112, v48, v49
    v_cvt_pk_bf16_f32 v113, v50, v51
    v_exp_f32 v56, v56
    v_exp_f32 v57, v57
    v_exp_f32 v58, v58
    v_exp_f32 v59, v59
    v_cvt_pk_bf16_f32 v114, v52, v53
    v_cvt_pk_bf16_f32 v115, v54, v55
    v_exp_f32 v60, v60
    v_exp_f32 v61, v61
    v_exp_f32 v62, v62
    v_exp_f32 v63, v63
    s_nop 0
    v_cvt_pk_bf16_f32 v116, v56, v57
    v_cvt_pk_bf16_f32 v117, v58, v59
    v_cvt_pk_bf16_f32 v118, v60, v61
    v_cvt_pk_bf16_f32 v119, v62, v63
    s_waitcnt lgkmcnt(5)
    s_nop 1
    v_mfma_f32_32x32x16_bf16 v[136:151], v[128:131], v[112:115], v[136:151]
    v_mfma_f32_32x32x16_bf16 v[136:151], v[132:135], v[116:119], v[136:151]
    s_waitcnt lgkmcnt(4)
    v_mfma_f32_32x32x16_bf16 v[48:63], v[20:23], v[8:11], v[96:111]
    ds_read_b128 v[16:19], v6 offset:8192
    v_add_u32 v7, v7, v12
    ds_read_b64_tr_b16 v[128:129], v7 offset:0
    ds_read_b64_tr_b16 v[130:131], v7 offset:256
    ds_read_b64_tr_b16 v[132:133], v7 offset:512
    ds_read_b64_tr_b16 v[134:135], v7 offset:768
    v_exp_f32 v32, v32
    v_exp_f32 v33, v33
    v_exp_f32 v34, v34
    v_exp_f32 v35, v35
    v_exp_f32 v36, v36
    v_exp_f32 v37, v37
    v_exp_f32 v38, v38
    v_exp_f32 v39, v39
    v_cvt_pk_bf16_f32 v112, v32, v33
    v_cvt_pk_bf16_f32 v113, v34, v35
    v_exp_f32 v40, v40
    v_exp_f32 v41, v41
    v_exp_f32 v42, v42
    v_exp_f32 v43, v43
    v_cvt_pk_bf16_f32 v114, v36, v37
    v_cvt_pk_bf16_f32 v115, v38, v39
    v_exp_f32 v44, v44
    v_exp_f32 v45, v45
    v_exp_f32 v46, v46
    v_exp_f32 v47, v47
    s_nop 0
    v_cvt_pk_bf16_f32 v116, v40, v41
    v_cvt_pk_bf16_f32 v117, v42, v43
    v_cvt_pk_bf16_f32 v118, v44, v45
    v_cvt_pk_bf16_f32 v119, v46, v47
    s_waitcnt lgkmcnt(5)
    s_nop 1
    v_mfma_f32_32x32x16_bf16 v[136:151], v[120:123], v[112:115], v[136:151]
    v_mfma_f32_32x32x16_bf16 v[136:151], v[124:127], v[116:119], v[136:151]
    s_waitcnt lgkmcnt(4)
    v_mfma_f32_32x32x16_bf16 v[32:47], v[16:19], v[8:11], v[80:95]
    v_add_u32 v7, v7, v12
    ds_read_b64_tr_b16 v[120:121], v7 offset:0
    ds_read_b64_tr_b16 v[122:123], v7 offset:256
    ds_read_b64_tr_b16 v[124:125], v7 offset:512
    ds_read_b64_tr_b16 v[126:127], v7 offset:768
    v_exp_f32 v48, v48
    v_exp_f32 v49, v49
    v_exp_f32 v50, v50
    v_exp_f32 v51, v51
    v_exp_f32 v52, v52
    v_exp_f32 v53, v53
    v_exp_f32 v54, v54
    v_exp_f32 v55, v55
    v_cvt_pk_bf16_f32 v112, v48, v49
    v_cvt_pk_bf16_f32 v113, v50, v51
    v_exp_f32 v56, v56
    v_exp_f32 v57, v57
    v_exp_f32 v58, v58
    v_exp_f32 v59, v59
    v_cvt_pk_bf16_f32 v114, v52, v53
    v_cvt_pk_bf16_f32 v115, v54, v55
    v_exp_f32 v60, v60
    v_exp_f32 v61, v61
    v_exp_f32 v62, v62
    v_exp_f32 v63, v63
    s_nop 0
    v_cvt_pk_bf16_f32 v116, v56, v57
    v_cvt_pk_bf16_f32 v117, v58, v59
    v_cvt_pk_bf16_f32 v118, v60, v61
    v_cvt_pk_bf16_f32 v119, v62, v63
    s_waitcnt lgkmcnt(4)
    s_nop 1
    v_mfma_f32_32x32x16_bf16 v[136:151], v[128:131], v[112:115], v[136:151]
    v_mfma_f32_32x32x16_bf16 v[136:151], v[132:135], v[116:119], v[136:151]
    v_exp_f32 v32, v32
    v_exp_f32 v33, v33
    v_exp_f32 v34, v34
    v_exp_f32 v35, v35
    v_exp_f32 v36, v36
    v_exp_f32 v37, v37
    v_exp_f32 v38, v38
    v_exp_f32 v39, v39
    v_cvt_pk_bf16_f32 v112, v32, v33
    v_cvt_pk_bf16_f32 v113, v34, v35
    v_exp_f32 v40, v40
    v_exp_f32 v41, v41
    v_exp_f32 v42, v42
    v_exp_f32 v43, v43
    v_cvt_pk_bf16_f32 v114, v36, v37
    v_cvt_pk_bf16_f32 v115, v38, v39
    v_exp_f32 v44, v44
    v_exp_f32 v45, v45
    v_exp_f32 v46, v46
    v_exp_f32 v47, v47
    s_nop 0
    v_cvt_pk_bf16_f32 v116, v40, v41
    v_cvt_pk_bf16_f32 v117, v42, v43
    v_cvt_pk_bf16_f32 v118, v44, v45
    v_cvt_pk_bf16_f32 v119, v46, v47
    s_waitcnt lgkmcnt(0)
    s_nop 1
    v_mfma_f32_32x32x16_bf16 v[136:151], v[120:123], v[112:115], v[136:151]
    v_mfma_f32_32x32x16_bf16 v[136:151], v[124:127], v[116:119], v[136:151]
    s_branch kB_fin
kB_slow:
    v_mov_b32 v24, v14
    v_mov_b32 v26, v6
    s_mov_b32 s47, s35
kB_34:
    s_cmp_eq_u32 s47, 0
    s_cbranch_scc1 kB_35
    ds_read_b128 v[16:19], v26
    s_waitcnt lgkmcnt(0)
    v_mfma_f32_32x32x16_bf16 v[32:47], v[16:19], v[8:11], 0
    s_nop 15
    v_max3_f32 v24, v32, v33, v24
    v_max3_f32 v24, v34, v35, v24
    v_max3_f32 v24, v36, v37, v24
    v_max3_f32 v24, v38, v39, v24
    v_max3_f32 v24, v40, v41, v24
    v_max3_f32 v24, v42, v43, v24
    v_max3_f32 v24, v44, v45, v24
    v_max3_f32 v24, v46, v47, v24
    v_add_u32 v26, 1024, v26
    s_sub_u32 s47, s47, 1
    s_branch kB_34
kB_35:
    ds_read_b128 v[16:19], v26
    s_waitcnt lgkmcnt(0)
    v_mfma_f32_32x32x16_bf16 v[32:47], v[16:19], v[8:11], v[80:95]
    s_nop 15
    v_max3_f32 v24, v32, v33, v24
    v_max3_f32 v24, v34, v35, v24
    v_max3_f32 v24, v36, v37, v24
    v_max3_f32 v24, v38, v39, v24
    v_max3_f32 v24, v40, v41, v24
    v_max3_f32 v24, v42, v43, v24
    v_max3_f32 v24, v44, v45, v24
    v_max3_f32 v24, v46, v47, v24
    v_mov_b32 v25, v24
    s_nop 1
    v_permlane32_swap_b32 v24, v25
    s_nop 1
    v_max_f32 v24, v24, v25
    v_sub_f32 v96, 0, v24
    v_mov_b32 v97, v96
    v_mov_b32 v98, v96
    v_mov_b32 v99, v96
    v_mov_b32 v100, v96
    v_mov_b32 v101, v96
    v_mov_b32 v102, v96
    v_mov_b32 v103, v96
    v_mov_b32 v104, v96
    v_mov_b32 v105, v96
    v_mov_b32 v106, v96
    v_mov_b32 v107, v96
    v_mov_b32 v108, v96
    v_mov_b32 v109, v96
    v_mov_b32 v110, v96
    v_mov_b32 v111, v96
    v_sub_f32 v80, v80, v24
    v_sub_f32 v81, v81, v24
    v_sub_f32 v82, v82, v24
    v_sub_f32 v83, v83, v24
    v_sub_f32 v84, v84, v24
    v_sub_f32 v85, v85, v24
    v_sub_f32 v86, v86, v24
    v_sub_f32 v87, v87, v24
    v_sub_f32 v88, v88, v24
    v_sub_f32 v89, v89, v24
    v_sub_f32 v90, v90, v24
    v_sub_f32 v91, v91, v24
    v_sub_f32 v92, v92, v24
    v_sub_f32 v93, v93, v24
    v_sub_f32 v94, v94, v24
    v_sub_f32 v95, v95, v24
    v_mov_b32 v136, 0
    v_mov_b32 v137, 0
    v_mov_b32 v138, 0
    v_mov_b32 v139, 0
    v_mov_b32 v140, 0
    v_mov_b32 v141, 0
    v_mov_b32 v142, 0
    v_mov_b32 v143, 0
    v_mov_b32 v144, 0
    v_mov_b32 v145, 0
    v_mov_b32 v146, 0
    v_mov_b32 v147, 0
    v_mov_b32 v148, 0
    v_mov_b32 v149, 0
    v_mov_b32 v150, 0
    v_mov_b32 v151, 0
    s_mov_b32 s47, s35
kB_36:
    s_cmp_eq_u32 s47, 0
    s_cbranch_scc1 kB_37
    ds_read_b128 v[16:19], v6
    ds_read_b64_tr_b16 v[120:121], v7 offset:0
    ds_read_b64_tr_b16 v[122:123], v7 offset:256
    ds_read_b64_tr_b16 v[124:125], v7 offset:512
    ds_read_b64_tr_b16 v[126:127], v7 offset:768
    s_waitcnt lgkmcnt(0)
    v_mfma_f32_32x32x16_bf16 v[32:47], v[16:19], v[8:11], v[96:111]
    s_nop 15
    v_exp_f32 v32, v32
    v_exp_f32 v33, v33
    v_exp_f32 v34, v34
    v_exp_f32 v35, v35
    v_exp_f32 v36, v36
    v_exp_f32 v37, v37
    v_exp_f32 v38, v38
    v_exp_f32 v39, v39
    v_cvt_pk_bf16_f32 v112, v32, v33
    v_cvt_pk_bf16_f32 v113, v34, v35
    v_exp_f32 v40, v40
    v_exp_f32 v41, v41
    v_exp_f32 v42, v42
    v_exp_f32 v43, v43
    v_cvt_pk_bf16_f32 v114, v36, v37
    v_cvt_pk_bf16_f32 v115, v38, v39
    v_exp_f32 v44, v44
    v_exp_f32 v45, v45
    v_exp_f32 v46, v46
    v_exp_f32 v47, v47
    s_nop 0
    v_cvt_pk_bf16_f32 v116, v40, v41
    v_cvt_pk_bf16_f32 v117, v42, v43
    v_cvt_pk_bf16_f32 v118, v44, v45
    v_cvt_pk_bf16_f32 v119, v46, v47
    s_nop 1
    v_mfma_f32_32x32x16_bf16 v[136:151], v[120:123], v[112:115], v[136:151]
    v_mfma_f32_32x32x16_bf16 v[136:151], v[124:127], v[116:119], v[136:151]
    v_add_u32 v6, 1024, v6
    v_add_u32 v7, v7, v12
    s_sub_u32 s47, s47, 1
    s_branch kB_36
kB_37:
    ds_read_b128 v[16:19], v6
    ds_read_b64_tr_b16 v[120:121], v7 offset:0
    ds_read_b64_tr_b16 v[122:123], v7 offset:256
    ds_read_b64_tr_b16 v[124:125], v7 offset:512
    ds_read_b64_tr_b16 v[126:127], v7 offset:768
    s_waitcnt lgkmcnt(0)
    v_mfma_f32_32x32x16_bf16 v[32:47], v[16:19], v[8:11], v[80:95]
    s_nop 15
    v_exp_f32 v32, v32
    v_exp_f32 v33, v33
    v_exp_f32 v34, v34
    v_exp_f32 v35, v35
    v_exp_f32 v36, v36
    v_exp_f32 v37, v37
    v_exp_f32 v38, v38
    v_exp_f32 v39, v39
    v_cvt_pk_bf16_f32 v112, v32, v33
    v_cvt_pk_bf16_f32 v113, v34, v35
    v_exp_f32 v40, v40
    v_exp_f32 v41, v41
    v_exp_f32 v42, v42
    v_exp_f32 v43, v43
    v_cvt_pk_bf16_f32 v114, v36, v37
    v_cvt_pk_bf16_f32 v115, v38, v39
    v_exp_f32 v44, v44
    v_exp_f32 v45, v45
    v_exp_f32 v46, v46
    v_exp_f32 v47, v47
    s_nop 0
    v_cvt_pk_bf16_f32 v116, v40, v41
    v_cvt_pk_bf16_f32 v117, v42, v43
    v_cvt_pk_bf16_f32 v118, v44, v45
    v_cvt_pk_bf16_f32 v119, v46, v47
    s_nop 1
    v_mfma_f32_32x32x16_bf16 v[136:151], v[120:123], v[112:115], v[136:151]
    v_mfma_f32_32x32x16_bf16 v[136:151], v[124:127], v[116:119], v[136:151]
kB_fin:
    s_nop 15
    v_rcp_f32 v25, v144
    s_nop 0
    v_mul_f32 v136, v136, v25
    v_mul_f32 v137, v137, v25
    v_mul_f32 v138, v138, v25
    v_mul_f32 v139, v139, v25
    v_mul_f32 v140, v140, v25
    v_mul_f32 v141, v141, v25
    v_mul_f32 v142, v142, v25
    v_mul_f32 v143, v143, v25
    v_cvt_pk_bf16_f32 v28, v136, v137
    v_cvt_pk_bf16_f32 v29, v138, v139
    v_cvt_pk_bf16_f32 v30, v140, v141
    v_cvt_pk_bf16_f32 v31, v142, v143
    s_lshl_b32 s40, s35, 5
    s_add_u32 s40, s40, s27
    s_lshl_b32 s40, s40, 10
    s_add_u32 s40, s40, 0xa00000
    buffer_store_dwordx4 v[28:31], v3, s[28:31], s40 offen
kB_done:
    s_endpgm
.globl kC_kernel
.p2align 8
.type kC_kernel,@function
kC_kernel:
    s_cmp_ge_u32 s2, 256
    s_cbranch_scc1 kC_done
    s_and_b32 s24, s2, 7
    s_lshr_b32 s25, s2, 3
    s_load_dwordx2 s[18:19], s[0:1], 48
    s_load_dwordx2 s[22:23], s[0:1], 80
    s_load_dwordx2 s[4:5], s[0:1], 16
    s_load_dwordx2 s[6:7], s[0:1], 56
    s_mul_i32 s26, s25, 37
    s_lshr_b32 s26, s26, 8
    s_mul_i32 s27, s26, 7
    s_sub_u32 s27, s25, s27
    s_lshr_b32 s28, s24, 1
    s_lshl_b32 s28, s28, 2
    s_add_u32 s26, s26, s28
    s_and_b32 s28, s24, 1
    s_mul_i32 s28, s28, 7
    s_add_u32 s27, s27, s28
    v_lshrrev_b32 v1, 6, v0
    v_and_b32 v2, 63, v0
    v_readfirstlane_b32 s33, v1
    s_mov_b32 s37, 0
    s_movk_i32 s34, 3584
    s_lshl_b32 s35, s27, 8
    s_waitcnt lgkmcnt(0)
    s_mov_b32 s12, s18
    s_mov_b32 s13, s19
    s_mov_b32 s14, 0x1c0000
    s_mov_b32 s15, 0x20000
    s_mov_b32 s28, s22
    s_mov_b32 s29, s23
    s_mov_b32 s30, 0x10000000
    s_mov_b32 s31, 0x20000
    s_cmp_ge_u32 s33, 4
    s_cbranch_scc1 kC_loader
    s_cmp_lg_u32 s33, 0
    s_cbranch_scc1 kC_38
kC_38:
    s_cmp_ge_u32 s25, 28
    s_cbranch_scc1 kC_idle
kC_39:
    v_and_b32 v12, 31, v2
    v_lshrrev_b32 v13, 5, v2
    v_lshlrev_b32 v14, 7, v12
    v_lshl_add_u32 v14, v13, 6, v14
    s_lshl_b32 s50, s26, 7
    s_lshl_b32 s51, s33, 5
    s_add_u32 s50, s50, s51
    s_lshl_b32 s50, s50, 7
    s_add_u32 s50, s50, 0x1480000
    buffer_load_dwordx4 v[16:19], v14, s[28:31], s50 offen offset:0
    buffer_load_dwordx4 v[20:23], v14, s[28:31], s50 offen offset:16
    buffer_load_dwordx4 v[24:27], v14, s[28:31], s50 offen offset:32
    buffer_load_dwordx4 v[28:31], v14, s[28:31], s50 offen offset:48
    v_lshlrev_b32 v15, 2, v12
    v_lshl_add_u32 v15, v13, 12, v15
    s_lshl_b32 s50, s27, 13
    s_lshl_b32 s51, s33, 7
    s_add_u32 s50, s50, s51
    s_add_u32 s50, s50, 0x1440000
    buffer_load_dword v32, v15, s[28:31], s50 offen offset:0
    buffer_load_dword v33, v15, s[28:31], s50 offen offset:512
    buffer_load_dword v34, v15, s[28:31], s50 offen offset:1024
    buffer_load_dword v35, v15, s[28:31], s50 offen offset:1536
    buffer_load_dword v36, v15, s[28:31], s50 offen offset:2048
    buffer_load_dword v37, v15, s[28:31], s50 offen offset:2560
    buffer_load_dword v38, v15, s[28:31], s50 offen offset:3072
    buffer_load_dword v39, v15, s[28:31], s50 offen offset:3584
    s_waitcnt vmcnt(0)
    v_pk_add_f32 v[16:17], v[16:17], v[18:19]
    v_pk_add_f32 v[20:21], v[20:21], v[22:23]
    v_pk_add_f32 v[24:25], v[24:25], v[26:27]
    v_pk_add_f32 v[28:29], v[28:29], v[30:31]
    v_pk_add_f32 v[16:17], v[16:17], v[20:21]
    v_pk_add_f32 v[24:25], v[24:25], v[28:29]
    v_pk_add_f32 v[16:17], v[16:17], v[24:25]
    v_add_f32 v32, v32, v33
    v_add_f32 v34, v34, v35
    v_add_f32 v36, v36, v37
    v_add_f32 v38, v38, v39
    v_add_f32 v32, v32, v34
    v_add_f32 v36, v36, v38
    v_add_f32 v32, v32, v36
    v_mov_b32 v18, v16
    v_mov_b32 v19, v17
    v_mov_b32 v33, v32
    s_nop 1
    v_permlane32_swap_b32 v16, v18
    v_permlane32_swap_b32 v17, v19
    v_permlane32_swap_b32 v32, v33
    s_nop 1
    v_add_f32 v16, v16, v18
    v_add_f32 v17, v17, v19
    v_add_f32 v32, v32, v33
    v_mul_f32 v16, 0x3b000000, v16
    v_mul_f32 v17, 0x3b000000, v17
    v_fma_f32 v17, -v16, v16, v17
    v_max_f32 v17, 0, v17
    v_add_f32 v17, 0x3727c5ac, v17
    v_rsq_f32 v20, v17
    s_nop 0
    v_mul_f32_e64 v21, -v16, v20
    v_lshlrev_b32 v22, 3, v12
    s_lshl_b32 s50, s33, 8
    s_add_u32 s50, s50, 131072
    v_add_u32 v22, s50, v22
    v_lshlrev_b32 v23, 2, v12
    s_lshl_b32 s50, s33, 7
    s_add_u32 s50, s50, 132096
    v_add_u32 v23, s50, v23
    s_mov_b32 exec_hi, 0
    ds_write_b64 v22, v[20:21]
    ds_write_b32 v23, v32
    s_mov_b32 exec_hi, -1
    s_waitcnt lgkmcnt(0)
    s_lshr_b32 s38, s33, 1
    s_and_b32 s39, s33, 1
    v_and_b32 v4, 63, v0
    v_lshlrev_b32 v5, 4, v4
    s_lshl_b32 s90, s38, 13
    v_add_u32 v8, s90, v5
    v_bfe_u32 v5, v4, 2, 2
    v_lshrrev_b32 v6, 5, v4
    v_lshlrev_b32 v6, 2, v6
    v_add_u32 v6, v6, v5
    v_lshlrev_b32 v6, 8, v6
    v_bfe_u32 v7, v4, 4, 1
    v_lshlrev_b32 v7, 1, v7
    v_bfe_u32 v12, v4, 1, 1
    v_add_u32 v7, v7, v12
    s_lshl_b32 s90, s39, 3
    v_add_u32 v7, s90, v7
    v_lshlrev_b32 v5, 2, v5
    v_xor_b32 v7, v7, v5
    v_xor_b32 v5, 4, v7
    v_and_b32 v4, 1, v4
    v_lshl_add_u32 v6, v4, 3, v6
    v_add_u32 v6, 16384, v6
    v_lshl_add_u32 v12, v7, 4, v6
    v_lshl_add_u32 v13, v5, 4, v6
    s_barrier
    ds_read_b64_tr_b16 v[24:25], v12 offset:0
    ds_read_b64_tr_b16 v[26:27], v12 offset:2048
    ds_read_b128 v[16:19], v8 offset:0
    ds_read_b128 v[20:23], v8 offset:4096
    ds_read_b64_tr_b16 v[28:29], v13 offset:0
    ds_read_b64_tr_b16 v[30:31], v13 offset:2048
    s_waitcnt lgkmcnt(0)
    v_mfma_f32_32x32x16_bf16 v[64:79], v[24:27], v[16:19], 0
    ds_read_b64_tr_b16 v[40:41], v12 offset:4096
    ds_read_b64_tr_b16 v[42:43], v12 offset:6144
    v_mfma_f32_32x32x16_bf16 v[96:111], v[24:27], v[20:23], 0
    ds_read_b128 v[32:35], v8 offset:1024
    ds_read_b128 v[36:39], v8 offset:5120
    v_mfma_f32_32x32x16_bf16 v[80:95], v[28:31], v[16:19], 0
    ds_read_b64_tr_b16 v[44:45], v13 offset:4096
    ds_read_b64_tr_b16 v[46:47], v13 offset:6144
    v_mfma_f32_32x32x16_bf16 v[112:127], v[28:31], v[20:23], 0
    s_waitcnt lgkmcnt(0)
    v_mfma_f32_32x32x16_bf16 v[64:79], v[40:43], v[32:35], v[64:79]
    ds_read_b64_tr_b16 v[24:25], v12 offset:8192
    ds_read_b64_tr_b16 v[26:27], v12 offset:10240
    v_mfma_f32_32x32x16_bf16 v[96:111], v[40:43], v[36:39], v[96:111]
    ds_read_b128 v[16:19], v8 offset:2048
    ds_read_b128 v[20:23], v8 offset:6144
    v_mfma_f32_32x32x16_bf16 v[80:95], v[44:47], v[32:35], v[80:95]
    ds_read_b64_tr_b16 v[28:29], v13 offset:8192
    ds_read_b64_tr_b16 v[30:31], v13 offset:10240
    v_mfma_f32_32x32x16_bf16 v[112:127], v[44:47], v[36:39], v[112:127]
    s_waitcnt lgkmcnt(0)
    v_mfma_f32_32x32x16_bf16 v[64:79], v[24:27], v[16:19], v[64:79]
    ds_read_b64_tr_b16 v[40:41], v12 offset:12288
    ds_read_b64_tr_b16 v[42:43], v12 offset:14336
    v_mfma_f32_32x32x16_bf16 v[96:111], v[24:27], v[20:23], v[96:111]
    ds_read_b128 v[32:35], v8 offset:3072
    ds_read_b128 v[36:39], v8 offset:7168
    v_mfma_f32_32x32x16_bf16 v[80:95], v[28:31], v[16:19], v[80:95]
    ds_read_b64_tr_b16 v[44:45], v13 offset:12288
    ds_read_b64_tr_b16 v[46:47], v13 offset:14336
    v_mfma_f32_32x32x16_bf16 v[112:127], v[28:31], v[20:23], v[112:127]
    s_waitcnt lgkmcnt(0)
    v_mfma_f32_32x32x16_bf16 v[64:79], v[40:43], v[32:35], v[64:79]
    s_barrier
    ds_read_b64_tr_b16 v[24:25], v12 offset:32768
    ds_read_b64_tr_b16 v[26:27], v12 offset:34816
    v_mfma_f32_32x32x16_bf16 v[96:111], v[40:43], v[36:39], v[96:111]
    ds_read_b128 v[16:19], v8 offset:32768
    ds_read_b128 v[20:23], v8 offset:36864
    v_mfma_f32_32x32x16_bf16 v[80:95], v[44:47], v[32:35], v[80:95]
    ds_read_b64_tr_b16 v[28:29], v13 offset:32768
    ds_read_b64_tr_b16 v[30:31], v13 offset:34816
    v_mfma_f32_32x32x16_bf16 v[112:127], v[44:47], v[36:39], v[112:127]
    s_waitcnt lgkmcnt(0)
    v_mfma_f32_32x32x16_bf16 v[64:79], v[24:27], v[16:19], v[64:79]
    ds_read_b64_tr_b16 v[40:41], v12 offset:36864
    ds_read_b64_tr_b16 v[42:43], v12 offset:38912
    v_mfma_f32_32x32x16_bf16 v[96:111], v[24:27], v[20:23], v[96:111]
    ds_read_b128 v[32:35], v8 offset:33792
    ds_read_b128 v[36:39], v8 offset:37888
    v_mfma_f32_32x32x16_bf16 v[80:95], v[28:31], v[16:19], v[80:95]
    ds_read_b64_tr_b16 v[44:45], v13 offset:36864
    ds_read_b64_tr_b16 v[46:47], v13 offset:38912
    v_mfma_f32_32x32x16_bf16 v[112:127], v[28:31], v[20:23], v[112:127]
    s_waitcnt lgkmcnt(0)
    v_mfma_f32_32x32x16_bf16 v[64:79], v[40:43], v[32:35], v[64:79]
    ds_read_b64_tr_b16 v[24:25], v12 offset:40960
    ds_read_b64_tr_b16 v[26:27], v12 offset:43008
    v_mfma_f32_32x32x16_bf16 v[96:111], v[40:43], v[36:39], v[96:111]
    ds_read_b128 v[16:19], v8 offset:34816
    ds_read_b128 v[20:23], v8 offset:38912
    v_mfma_f32_32x32x16_bf16 v[80:95], v[44:47], v[32:35], v[80:95]
    ds_read_b64_tr_b16 v[28:29], v13 offset:40960
    ds_read_b64_tr_b16 v[30:31], v13 offset:43008
    v_mfma_f32_32x32x16_bf16 v[112:127], v[44:47], v[36:39], v[112:127]
    s_waitcnt lgkmcnt(0)
    v_mfma_f32_32x32x16_bf16 v[64:79], v[24:27], v[16:19], v[64:79]
    ds_read_b64_tr_b16 v[40:41], v12 offset:45056
    ds_read_b64_tr_b16 v[42:43], v12 offset:47104
    v_mfma_f32_32x32x16_bf16 v[96:111], v[24:27], v[20:23], v[96:111]
    ds_read_b128 v[32:35], v8 offset:35840
    ds_read_b128 v[36:39], v8 offset:39936
    v_mfma_f32_32x32x16_bf16 v[80:95], v[28:31], v[16:19], v[80:95]
    ds_read_b64_tr_b16 v[44:45], v13 offset:45056
    ds_read_b64_tr_b16 v[46:47], v13 offset:47104
    v_mfma_f32_32x32x16_bf16 v[112:127], v[28:31], v[20:23], v[112:127]
    s_waitcnt lgkmcnt(0)
    v_mfma_f32_32x32x16_bf16 v[64:79], v[40:43], v[32:35], v[64:79]
    s_barrier
    v_add_u32 v8, 0x10000, v8
    v_add_u32 v12, 0x10000, v12
    v_add_u32 v13, 0x10000, v13
    ds_read_b64_tr_b16 v[24:25], v12 offset:0
    ds_read_b64_tr_b16 v[26:27], v12 offset:2048
    v_mfma_f32_32x32x16_bf16 v[96:111], v[40:43], v[36:39], v[96:111]
    ds_read_b128 v[16:19], v8 offset:0
    ds_read_b128 v[20:23], v8 offset:4096
    v_mfma_f32_32x32x16_bf16 v[80:95], v[44:47], v[32:35], v[80:95]
    ds_read_b64_tr_b16 v[28:29], v13 offset:0
    ds_read_b64_tr_b16 v[30:31], v13 offset:2048
    v_mfma_f32_32x32x16_bf16 v[112:127], v[44:47], v[36:39], v[112:127]
    s_waitcnt lgkmcnt(0)
    v_mfma_f32_32x32x16_bf16 v[64:79], v[24:27], v[16:19], v[64:79]
    ds_read_b64_tr_b16 v[40:41], v12 offset:4096
    ds_read_b64_tr_b16 v[42:43], v12 offset:6144
    v_mfma_f32_32x32x16_bf16 v[96:111], v[24:27], v[20:23], v[96:111]
    ds_read_b128 v[32:35], v8 offset:1024
    ds_read_b128 v[36:39], v8 offset:5120
    v_mfma_f32_32x32x16_bf16 v[80:95], v[28:31], v[16:19], v[80:95]
    ds_read_b64_tr_b16 v[44:45], v13 offset:4096
    ds_read_b64_tr_b16 v[46:47], v13 offset:6144
    v_mfma_f32_32x32x16_bf16 v[112:127], v[28:31], v[20:23], v[112:127]
    s_waitcnt lgkmcnt(0)
    v_mfma_f32_32x32x16_bf16 v[64:79], v[40:43], v[32:35], v[64:79]
    ds_read_b64_tr_b16 v[24:25], v12 offset:8192
    ds_read_b64_tr_b16 v[26:27], v12 offset:10240
    v_mfma_f32_32x32x16_bf16 v[96:111], v[40:43], v[36:39], v[96:111]
    ds_read_b128 v[16:19], v8 offset:2048
    ds_read_b128 v[20:23], v8 offset:6144
    v_mfma_f32_32x32x16_bf16 v[80:95], v[44:47], v[32:35], v[80:95]
    ds_read_b64_tr_b16 v[28:29], v13 offset:8192
    ds_read_b64_tr_b16 v[30:31], v13 offset:10240
    v_mfma_f32_32x32x16_bf16 v[112:127], v[44:47], v[36:39], v[112:127]
    s_waitcnt lgkmcnt(0)
    v_mfma_f32_32x32x16_bf16 v[64:79], v[24:27], v[16:19], v[64:79]
    ds_read_b64_tr_b16 v[40:41], v12 offset:12288
    ds_read_b64_tr_b16 v[42:43], v12 offset:14336
    v_mfma_f32_32x32x16_bf16 v[96:111], v[24:27], v[20:23], v[96:111]
    ds_read_b128 v[32:35], v8 offset:3072
    ds_read_b128 v[36:39], v8 offset:7168
    v_mfma_f32_32x32x16_bf16 v[80:95], v[28:31], v[16:19], v[80:95]
    ds_read_b64_tr_b16 v[44:45], v13 offset:12288
    ds_read_b64_tr_b16 v[46:47], v13 offset:14336
    v_mfma_f32_32x32x16_bf16 v[112:127], v[28:31], v[20:23], v[112:127]
    s_waitcnt lgkmcnt(0)
    v_mfma_f32_32x32x16_bf16 v[64:79], v[40:43], v[32:35], v[64:79]
    s_barrier
    ds_read_b64_tr_b16 v[24:25], v12 offset:32768
    ds_read_b64_tr_b16 v[26:27], v12 offset:34816
    v_mfma_f32_32x32x16_bf16 v[96:111], v[40:43], v[36:39], v[96:111]
    ds_read_b128 v[16:19], v8 offset:32768
    ds_read_b128 v[20:23], v8 offset:36864
    v_mfma_f32_32x32x16_bf16 v[80:95], v[44:47], v[32:35], v[80:95]
    ds_read_b64_tr_b16 v[28:29], v13 offset:32768
    ds_read_b64_tr_b16 v[30:31], v13 offset:34816
    v_mfma_f32_32x32x16_bf16 v[112:127], v[44:47], v[36:39], v[112:127]
    s_waitcnt lgkmcnt(0)
    v_mfma_f32_32x32x16_bf16 v[64:79], v[24:27], v[16:19], v[64:79]
    ds_read_b64_tr_b16 v[40:41], v12 offset:36864
    ds_read_b64_tr_b16 v[42:43], v12 offset:38912
    v_mfma_f32_32x32x16_bf16 v[96:111], v[24:27], v[20:23], v[96:111]
    ds_read_b128 v[32:35], v8 offset:33792
    ds_read_b128 v[36:39], v8 offset:37888
    v_mfma_f32_32x32x16_bf16 v[80:95], v[28:31], v[16:19], v[80:95]
    ds_read_b64_tr_b16 v[44:45], v13 offset:36864
    ds_read_b64_tr_b16 v[46:47], v13 offset:38912
    v_mfma_f32_32x32x16_bf16 v[112:127], v[28:31], v[20:23], v[112:127]
    s_waitcnt lgkmcnt(0)
    v_mfma_f32_32x32x16_bf16 v[64:79], v[40:43], v[32:35], v[64:79]
    ds_read_b64_tr_b16 v[24:25], v12 offset:40960
    ds_read_b64_tr_b16 v[26:27], v12 offset:43008
    v_mfma_f32_32x32x16_bf16 v[96:111], v[40:43], v[36:39], v[96:111]
    ds_read_b128 v[16:19], v8 offset:34816
    ds_read_b128 v[20:23], v8 offset:38912
    v_mfma_f32_32x32x16_bf16 v[80:95], v[44:47], v[32:35], v[80:95]
    ds_read_b64_tr_b16 v[28:29], v13 offset:40960
    ds_read_b64_tr_b16 v[30:31], v13 offset:43008
    v_mfma_f32_32x32x16_bf16 v[112:127], v[44:47], v[36:39], v[112:127]
    s_waitcnt lgkmcnt(0)
    v_mfma_f32_32x32x16_bf16 v[64:79], v[24:27], v[16:19], v[64:79]
    ds_read_b64_tr_b16 v[40:41], v12 offset:45056
    ds_read_b64_tr_b16 v[42:43], v12 offset:47104
    v_mfma_f32_32x32x16_bf16 v[96:111], v[24:27], v[20:23], v[96:111]
    ds_read_b128 v[32:35], v8 offset:35840
    ds_read_b128 v[36:39], v8 offset:39936
    v_mfma_f32_32x32x16_bf16 v[80:95], v[28:31], v[16:19], v[80:95]
    ds_read_b64_tr_b16 v[44:45], v13 offset:45056
    ds_read_b64_tr_b16 v[46:47], v13 offset:47104
    v_mfma_f32_32x32x16_bf16 v[112:127], v[28:31], v[20:23], v[112:127]
    s_waitcnt lgkmcnt(0)
    v_mfma_f32_32x32x16_bf16 v[64:79], v[40:43], v[32:35], v[64:79]
    s_barrier
    v_add_u32 v8, 0xffff0000, v8
    v_add_u32 v12, 0xffff0000, v12
    v_add_u32 v13, 0xffff0000, v13
    ds_read_b64_tr_b16 v[24:25], v12 offset:0
    ds_read_b64_tr_b16 v[26:27], v12 offset:2048
    v_mfma_f32_32x32x16_bf16 v[96:111], v[40:43], v[36:39], v[96:111]
    ds_read_b128 v[16:19], v8 offset:0
    ds_read_b128 v[20:23], v8 offset:4096
    v_mfma_f32_32x32x16_bf16 v[80:95], v[44:47], v[32:35], v[80:95]
    ds_read_b64_tr_b16 v[28:29], v13 offset:0
    ds_read_b64_tr_b16 v[30:31], v13 offset:2048
    v_mfma_f32_32x32x16_bf16 v[112:127], v[44:47], v[36:39], v[112:127]
    s_waitcnt lgkmcnt(0)
    v_mfma_f32_32x32x16_bf16 v[64:79], v[24:27], v[16:19], v[64:79]
    ds_read_b64_tr_b16 v[40:41], v12 offset:4096
    ds_read_b64_tr_b16 v[42:43], v12 offset:6144
    v_mfma_f32_32x32x16_bf16 v[96:111], v[24:27], v[20:23], v[96:111]
    ds_read_b128 v[32:35], v8 offset:1024
    ds_read_b128 v[36:39], v8 offset:5120
    v_mfma_f32_32x32x16_bf16 v[80:95], v[28:31], v[16:19], v[80:95]
    ds_read_b64_tr_b16 v[44:45], v13 offset:4096
    ds_read_b64_tr_b16 v[46:47], v13 offset:6144
    v_mfma_f32_32x32x16_bf16 v[112:127], v[28:31], v[20:23], v[112:127]
    s_waitcnt lgkmcnt(0)
    v_mfma_f32_32x32x16_bf16 v[64:79], v[40:43], v[32:35], v[64:79]
    ds_read_b64_tr_b16 v[24:25], v12 offset:8192
    ds_read_b64_tr_b16 v[26:27], v12 offset:10240
    v_mfma_f32_32x32x16_bf16 v[96:111], v[40:43], v[36:39], v[96:111]
    ds_read_b128 v[16:19], v8 offset:2048
    ds_read_b128 v[20:23], v8 offset:6144
    v_mfma_f32_32x32x16_bf16 v[80:95], v[44:47], v[32:35], v[80:95]
    ds_read_b64_tr_b16 v[28:29], v13 offset:8192
    ds_read_b64_tr_b16 v[30:31], v13 offset:10240
    v_mfma_f32_32x32x16_bf16 v[112:127], v[44:47], v[36:39], v[112:127]
    s_waitcnt lgkmcnt(0)
    v_mfma_f32_32x32x16_bf16 v[64:79], v[24:27], v[16:19], v[64:79]
    ds_read_b64_tr_b16 v[40:41], v12 offset:12288
    ds_read_b64_tr_b16 v[42:43], v12 offset:14336
    v_mfma_f32_32x32x16_bf16 v[96:111], v[24:27], v[20:23], v[96:111]
    ds_read_b128 v[32:35], v8 offset:3072
    ds_read_b128 v[36:39], v8 offset:7168
    v_mfma_f32_32x32x16_bf16 v[80:95], v[28:31], v[16:19], v[80:95]
    ds_read_b64_tr_b16 v[44:45], v13 offset:12288
    ds_read_b64_tr_b16 v[46:47], v13 offset:14336
    v_mfma_f32_32x32x16_bf16 v[112:127], v[28:31], v[20:23], v[112:127]
    s_waitcnt lgkmcnt(0)
    v_mfma_f32_32x32x16_bf16 v[64:79], v[40:43], v[32:35], v[64:79]
    s_barrier
    ds_read_b64_tr_b16 v[24:25], v12 offset:32768
    ds_read_b64_tr_b16 v[26:27], v12 offset:34816
    v_mfma_f32_32x32x16_bf16 v[96:111], v[40:43], v[36:39], v[96:111]
    ds_read_b128 v[16:19], v8 offset:32768
    ds_read_b128 v[20:23], v8 offset:36864
    v_mfma_f32_32x32x16_bf16 v[80:95], v[44:47], v[32:35], v[80:95]
    ds_read_b64_tr_b16 v[28:29], v13 offset:32768
    ds_read_b64_tr_b16 v[30:31], v13 offset:34816
    v_mfma_f32_32x32x16_bf16 v[112:127], v[44:47], v[36:39], v[112:127]
    s_waitcnt lgkmcnt(0)
    v_mfma_f32_32x32x16_bf16 v[64:79], v[24:27], v[16:19], v[64:79]
    ds_read_b64_tr_b16 v[40:41], v12 offset:36864
    ds_read_b64_tr_b16 v[42:43], v12 offset:38912
    v_mfma_f32_32x32x16_bf16 v[96:111], v[24:27], v[20:23], v[96:111]
    ds_read_b128 v[32:35], v8 offset:33792
    ds_read_b128 v[36:39], v8 offset:37888
    v_mfma_f32_32x32x16_bf16 v[80:95], v[28:31], v[16:19], v[80:95]
    ds_read_b64_tr_b16 v[44:45], v13 offset:36864
    ds_read_b64_tr_b16 v[46:47], v13 offset:38912
    v_mfma_f32_32x32x16_bf16 v[112:127], v[28:31], v[20:23], v[112:127]
    s_waitcnt lgkmcnt(0)
    v_mfma_f32_32x32x16_bf16 v[64:79], v[40:43], v[32:35], v[64:79]
    ds_read_b64_tr_b16 v[24:25], v12 offset:40960
    ds_read_b64_tr_b16 v[26:27], v12 offset:43008
    v_mfma_f32_32x32x16_bf16 v[96:111], v[40:43], v[36:39], v[96:111]
    ds_read_b128 v[16:19], v8 offset:34816
    ds_read_b128 v[20:23], v8 offset:38912
    v_mfma_f32_32x32x16_bf16 v[80:95], v[44:47], v[32:35], v[80:95]
    ds_read_b64_tr_b16 v[28:29], v13 offset:40960
    ds_read_b64_tr_b16 v[30:31], v13 offset:43008
    v_mfma_f32_32x32x16_bf16 v[112:127], v[44:47], v[36:39], v[112:127]
    s_waitcnt lgkmcnt(0)
    v_mfma_f32_32x32x16_bf16 v[64:79], v[24:27], v[16:19], v[64:79]
    ds_read_b64_tr_b16 v[40:41], v12 offset:45056
    ds_read_b64_tr_b16 v[42:43], v12 offset:47104
    v_mfma_f32_32x32x16_bf16 v[96:111], v[24:27], v[20:23], v[96:111]
    ds_read_b128 v[32:35], v8 offset:35840
    ds_read_b128 v[36:39], v8 offset:39936
    v_mfma_f32_32x32x16_bf16 v[80:95], v[28:31], v[16:19], v[80:95]
    ds_read_b64_tr_b16 v[44:45], v13 offset:45056
    ds_read_b64_tr_b16 v[46:47], v13 offset:47104
    v_mfma_f32_32x32x16_bf16 v[112:127], v[28:31], v[20:23], v[112:127]
    s_waitcnt lgkmcnt(0)
    v_mfma_f32_32x32x16_bf16 v[64:79], v[40:43], v[32:35], v[64:79]
    s_barrier
    v_add_u32 v8, 0x10000, v8
    v_add_u32 v12, 0x10000, v12
    v_add_u32 v13, 0x10000, v13
    ds_read_b64_tr_b16 v[24:25], v12 offset:0
    ds_read_b64_tr_b16 v[26:27], v12 offset:2048
    v_mfma_f32_32x32x16_bf16 v[96:111], v[40:43], v[36:39], v[96:111]
    ds_read_b128 v[16:19], v8 offset:0
    ds_read_b128 v[20:23], v8 offset:4096
    v_mfma_f32_32x32x16_bf16 v[80:95], v[44:47], v[32:35], v[80:95]
    ds_read_b64_tr_b16 v[28:29], v13 offset:0
    ds_read_b64_tr_b16 v[30:31], v13 offset:2048
    v_mfma_f32_32x32x16_bf16 v[112:127], v[44:47], v[36:39], v[112:127]
    s_waitcnt lgkmcnt(0)
    v_mfma_f32_32x32x16_bf16 v[64:79], v[24:27], v[16:19], v[64:79]
    ds_read_b64_tr_b16 v[40:41], v12 offset:4096
    ds_read_b64_tr_b16 v[42:43], v12 offset:6144
    v_mfma_f32_32x32x16_bf16 v[96:111], v[24:27], v[20:23], v[96:111]
    ds_read_b128 v[32:35], v8 offset:1024
    ds_read_b128 v[36:39], v8 offset:5120
    v_mfma_f32_32x32x16_bf16 v[80:95], v[28:31], v[16:19], v[80:95]
    ds_read_b64_tr_b16 v[44:45], v13 offset:4096
    ds_read_b64_tr_b16 v[46:47], v13 offset:6144
    v_mfma_f32_32x32x16_bf16 v[112:127], v[28:31], v[20:23], v[112:127]
    s_waitcnt lgkmcnt(0)
    v_mfma_f32_32x32x16_bf16 v[64:79], v[40:43], v[32:35], v[64:79]
    ds_read_b64_tr_b16 v[24:25], v12 offset:8192
    ds_read_b64_tr_b16 v[26:27], v12 offset:10240
    v_mfma_f32_32x32x16_bf16 v[96:111], v[40:43], v[36:39], v[96:111]
    ds_read_b128 v[16:19], v8 offset:2048
    ds_read_b128 v[20:23], v8 offset:6144
    v_mfma_f32_32x32x16_bf16 v[80:95], v[44:47], v[32:35], v[80:95]
    ds_read_b64_tr_b16 v[28:29], v13 offset:8192
    ds_read_b64_tr_b16 v[30:31], v13 offset:10240
    v_mfma_f32_32x32x16_bf16 v[112:127], v[44:47], v[36:39], v[112:127]
    s_waitcnt lgkmcnt(0)
    v_mfma_f32_32x32x16_bf16 v[64:79], v[24:27], v[16:19], v[64:79]
    ds_read_b64_tr_b16 v[40:41], v12 offset:12288
    ds_read_b64_tr_b16 v[42:43], v12 offset:14336
    v_mfma_f32_32x32x16_bf16 v[96:111], v[24:27], v[20:23], v[96:111]
    ds_read_b128 v[32:35], v8 offset:3072
    ds_read_b128 v[36:39], v8 offset:7168
    v_mfma_f32_32x32x16_bf16 v[80:95], v[28:31], v[16:19], v[80:95]
    ds_read_b64_tr_b16 v[44:45], v13 offset:12288
    ds_read_b64_tr_b16 v[46:47], v13 offset:14336
    v_mfma_f32_32x32x16_bf16 v[112:127], v[28:31], v[20:23], v[112:127]
    s_waitcnt lgkmcnt(0)
    v_mfma_f32_32x32x16_bf16 v[64:79], v[40:43], v[32:35], v[64:79]
    s_barrier
    ds_read_b64_tr_b16 v[24:25], v12 offset:32768
    ds_read_b64_tr_b16 v[26:27], v12 offset:34816
    v_mfma_f32_32x32x16_bf16 v[96:111], v[40:43], v[36:39], v[96:111]
    ds_read_b128 v[16:19], v8 offset:32768
    ds_read_b128 v[20:23], v8 offset:36864
    v_mfma_f32_32x32x16_bf16 v[80:95], v[44:47], v[32:35], v[80:95]
    ds_read_b64_tr_b16 v[28:29], v13 offset:32768
    ds_read_b64_tr_b16 v[30:31], v13 offset:34816
    v_mfma_f32_32x32x16_bf16 v[112:127], v[44:47], v[36:39], v[112:127]
    s_waitcnt lgkmcnt(0)
    v_mfma_f32_32x32x16_bf16 v[64:79], v[24:27], v[16:19], v[64:79]
    ds_read_b64_tr_b16 v[40:41], v12 offset:36864
    ds_read_b64_tr_b16 v[42:43], v12 offset:38912
    v_mfma_f32_32x32x16_bf16 v[96:111], v[24:27], v[20:23], v[96:111]
    ds_read_b128 v[32:35], v8 offset:33792
    ds_read_b128 v[36:39], v8 offset:37888
    v_mfma_f32_32x32x16_bf16 v[80:95], v[28:31], v[16:19], v[80:95]
    ds_read_b64_tr_b16 v[44:45], v13 offset:36864
    ds_read_b64_tr_b16 v[46:47], v13 offset:38912
    v_mfma_f32_32x32x16_bf16 v[112:127], v[28:31], v[20:23], v[112:127]
    s_waitcnt lgkmcnt(0)
    v_mfma_f32_32x32x16_bf16 v[64:79], v[40:43], v[32:35], v[64:79]
    ds_read_b64_tr_b16 v[24:25], v12 offset:40960
    ds_read_b64_tr_b16 v[26:27], v12 offset:43008
    v_mfma_f32_32x32x16_bf16 v[96:111], v[40:43], v[36:39], v[96:111]
    ds_read_b128 v[16:19], v8 offset:34816
    ds_read_b128 v[20:23], v8 offset:38912
    v_mfma_f32_32x32x16_bf16 v[80:95], v[44:47], v[32:35], v[80:95]
    ds_read_b64_tr_b16 v[28:29], v13 offset:40960
    ds_read_b64_tr_b16 v[30:31], v13 offset:43008
    v_mfma_f32_32x32x16_bf16 v[112:127], v[44:47], v[36:39], v[112:127]
    s_waitcnt lgkmcnt(0)
    v_mfma_f32_32x32x16_bf16 v[64:79], v[24:27], v[16:19], v[64:79]
    ds_read_b64_tr_b16 v[40:41], v12 offset:45056
    ds_read_b64_tr_b16 v[42:43], v12 offset:47104
    v_mfma_f32_32x32x16_bf16 v[96:111], v[24:27], v[20:23], v[96:111]
    ds_read_b128 v[32:35], v8 offset:35840
    ds_read_b128 v[36:39], v8 offset:39936
    v_mfma_f32_32x32x16_bf16 v[80:95], v[28:31], v[16:19], v[80:95]
    ds_read_b64_tr_b16 v[44:45], v13 offset:45056
    ds_read_b64_tr_b16 v[46:47], v13 offset:47104
    v_mfma_f32_32x32x16_bf16 v[112:127], v[28:31], v[20:23], v[112:127]
    s_waitcnt lgkmcnt(0)
    v_mfma_f32_32x32x16_bf16 v[64:79], v[40:43], v[32:35], v[64:79]
    v_mfma_f32_32x32x16_bf16 v[96:111], v[40:43], v[36:39], v[96:111]
    v_mfma_f32_32x32x16_bf16 v[80:95], v[44:47], v[32:35], v[80:95]
    v_mfma_f32_32x32x16_bf16 v[112:127], v[44:47], v[36:39], v[112:127]
    v_and_b32 v4, 31, v2
    v_lshlrev_b32 v4, 3, v4
    s_lshl_b32 s46, s38, 9
    s_add_u32 s46, s46, 131072
    v_add_u32 v4, s46, v4
    ds_read_b64 v[52:53], v4
    ds_read_b64 v[54:55], v4 offset:256
    v_lshrrev_b32 v51, 5, v2
    v_lshlrev_b32 v51, 4, v51
    s_lshl_b32 s46, s39, 8
    s_add_u32 s46, s46, 132096
    v_add_u32 v51, s46, v51
    ds_read_b128 v[16:19], v51 offset:0
    ds_read_b128 v[20:23], v51 offset:32
    ds_read_b128 v[24:27], v51 offset:64
    ds_read_b128 v[28:31], v51 offset:96
    ds_read_b128 v[32:35], v51 offset:128
    ds_read_b128 v[36:39], v51 offset:160
    ds_read_b128 v[40:43], v51 offset:192
    ds_read_b128 v[44:47], v51 offset:224
    s_waitcnt lgkmcnt(0)
    v_pk_mul_f32 v[56:57], v[16:17], v[52:53] op_sel:[0,1] op_sel_hi:[1,1]
    v_pk_mul_f32 v[58:59], v[18:19], v[52:53] op_sel:[0,1] op_sel_hi:[1,1]
    v_pk_mul_f32 v[60:61], v[20:21], v[52:53] op_sel:[0,1] op_sel_hi:[1,1]
    v_pk_mul_f32 v[62:63], v[22:23], v[52:53] op_sel:[0,1] op_sel_hi:[1,1]
    v_pk_fma_f32 v[64:65], v[64:65], v[52:53], v[56:57] op_sel_hi:[1,0,1]
    v_pk_mul_f32 v[56:57], v[24:25], v[52:53] op_sel:[0,1] op_sel_hi:[1,1]
    v_pk_fma_f32 v[66:67], v[66:67], v[52:53], v[58:59] op_sel_hi:[1,0,1]
    v_pk_mul_f32 v[58:59], v[26:27], v[52:53] op_sel:[0,1] op_sel_hi:[1,1]
    v_pk_fma_f32 v[68:69], v[68:69], v[52:53], v[60:61] op_sel_hi:[1,0,1]
    v_pk_mul_f32 v[60:61], v[28:29], v[52:53] op_sel:[0,1] op_sel_hi:[1,1]
    v_pk_fma_f32 v[70:71], v[70:71], v[52:53], v[62:63] op_sel_hi:[1,0,1]
    v_pk_mul_f32 v[62:63], v[30:31], v[52:53] op_sel:[0,1] op_sel_hi:[1,1]
    v_pk_fma_f32 v[72:73], v[72:73], v[52:53], v[56:57] op_sel_hi:[1,0,1]
    v_pk_fma_f32 v[74:75], v[74:75], v[52:53], v[58:59] op_sel_hi:[1,0,1]
    v_pk_fma_f32 v[76:77], v[76:77], v[52:53], v[60:61] op_sel_hi:[1,0,1]
    v_pk_fma_f32 v[78:79], v[78:79], v[52:53], v[62:63] op_sel_hi:[1,0,1]
    v_pk_mul_f32 v[56:57], v[32:33], v[52:53] op_sel:[0,1] op_sel_hi:[1,1]
    v_pk_mul_f32 v[58:59], v[34:35], v[52:53] op_sel:[0,1] op_sel_hi:[1,1]
    v_pk_mul_f32 v[60:61], v[36:37], v[52:53] op_sel:[0,1] op_sel_hi:[1,1]
    v_pk_mul_f32 v[62:63], v[38:39], v[52:53] op_sel:[0,1] op_sel_hi:[1,1]
    v_pk_fma_f32 v[80:81], v[80:81], v[52:53], v[56:57] op_sel_hi:[1,0,1]
    v_pk_mul_f32 v[56:57], v[40:41], v[52:53] op_sel:[0,1] op_sel_hi:[1,1]
    v_pk_fma_f32 v[82:83], v[82:83], v[52:53], v[58:59] op_sel_hi:[1,0,1]
    v_pk_mul_f32 v[58:59], v[42:43], v[52:53] op_sel:[0,1] op_sel_hi:[1,1]
    v_pk_fma_f32 v[84:85], v[84:85], v[52:53], v[60:61] op_sel_hi:[1,0,1]
    v_pk_mul_f32 v[60:61], v[44:45], v[52:53] op_sel:[0,1] op_sel_hi:[1,1]
    v_pk_fma_f32 v[86:87], v[86:87], v[52:53], v[62:63] op_sel_hi:[1,0,1]
    v_pk_mul_f32 v[62:63], v[46:47], v[52:53] op_sel:[0,1] op_sel_hi:[1,1]
    v_pk_fma_f32 v[88:89], v[88:89], v[52:53], v[56:57] op_sel_hi:[1,0,1]
    v_pk_fma_f32 v[90:91], v[90:91], v[52:53], v[58:59] op_sel_hi:[1,0,1]
    v_pk_fma_f32 v[92:93], v[92:93], v[52:53], v[60:61] op_sel_hi:[1,0,1]
    v_pk_fma_f32 v[94:95], v[94:95], v[52:53], v[62:63] op_sel_hi:[1,0,1]
    v_pk_mul_f32 v[56:57], v[16:17], v[54:55] op_sel:[0,1] op_sel_hi:[1,1]
    v_pk_mul_f32 v[58:59], v[18:19], v[54:55] op_sel:[0,1] op_sel_hi:[1,1]
    v_pk_mul_f32 v[60:61], v[20:21], v[54:55] op_sel:[0,1] op_sel_hi:[1,1]
    v_pk_mul_f32 v[62:63], v[22:23], v[54:55] op_sel:[0,1] op_sel_hi:[1,1]
    v_pk_fma_f32 v[96:97], v[96:97], v[54:55], v[56:57] op_sel_hi:[1,0,1]
    v_pk_mul_f32 v[56:57], v[24:25], v[54:55] op_sel:[0,1] op_sel_hi:[1,1]
    v_pk_fma_f32 v[98:99], v[98:99], v[54:55], v[58:59] op_sel_hi:[1,0,1]
    v_pk_mul_f32 v[58:59], v[26:27], v[54:55] op_sel:[0,1] op_sel_hi:[1,1]
    v_pk_fma_f32 v[100:101], v[100:101], v[54:55], v[60:61] op_sel_hi:[1,0,1]
    v_pk_mul_f32 v[60:61], v[28:29], v[54:55] op_sel:[0,1] op_sel_hi:[1,1]
    v_pk_fma_f32 v[102:103], v[102:103], v[54:55], v[62:63] op_sel_hi:[1,0,1]
    v_pk_mul_f32 v[62:63], v[30:31], v[54:55] op_sel:[0,1] op_sel_hi:[1,1]
    v_pk_fma_f32 v[104:105], v[104:105], v[54:55], v[56:57] op_sel_hi:[1,0,1]
    v_pk_fma_f32 v[106:107], v[106:107], v[54:55], v[58:59] op_sel_hi:[1,0,1]
    v_pk_fma_f32 v[108:109], v[108:109], v[54:55], v[60:61] op_sel_hi:[1,0,1]
    v_pk_fma_f32 v[110:111], v[110:111], v[54:55], v[62:63] op_sel_hi:[1,0,1]
    v_pk_mul_f32 v[56:57], v[32:33], v[54:55] op_sel:[0,1] op_sel_hi:[1,1]
    v_pk_mul_f32 v[58:59], v[34:35], v[54:55] op_sel:[0,1] op_sel_hi:[1,1]
    v_pk_mul_f32 v[60:61], v[36:37], v[54:55] op_sel:[0,1] op_sel_hi:[1,1]
    v_pk_mul_f32 v[62:63], v[38:39], v[54:55] op_sel:[0,1] op_sel_hi:[1,1]
    v_pk_fma_f32 v[112:113], v[112:113], v[54:55], v[56:57] op_sel_hi:[1,0,1]
    v_pk_mul_f32 v[56:57], v[40:41], v[54:55] op_sel:[0,1] op_sel_hi:[1,1]
    v_pk_fma_f32 v[114:115], v[114:115], v[54:55], v[58:59] op_sel_hi:[1,0,1]
    v_pk_mul_f32 v[58:59], v[42:43], v[54:55] op_sel:[0,1] op_sel_hi:[1,1]
    v_pk_fma_f32 v[116:117], v[116:117], v[54:55], v[60:61] op_sel_hi:[1,0,1]
    v_pk_mul_f32 v[60:61], v[44:45], v[54:55] op_sel:[0,1] op_sel_hi:[1,1]
    v_pk_fma_f32 v[118:119], v[118:119], v[54:55], v[62:63] op_sel_hi:[1,0,1]
    v_pk_mul_f32 v[62:63], v[46:47], v[54:55] op_sel:[0,1] op_sel_hi:[1,1]
    v_pk_fma_f32 v[120:121], v[120:121], v[54:55], v[56:57] op_sel_hi:[1,0,1]
    v_pk_fma_f32 v[122:123], v[122:123], v[54:55], v[58:59] op_sel_hi:[1,0,1]
    v_pk_fma_f32 v[124:125], v[124:125], v[54:55], v[60:61] op_sel_hi:[1,0,1]
    v_pk_fma_f32 v[126:127], v[126:127], v[54:55], v[62:63] op_sel_hi:[1,0,1]
    v_mov_b32 v4, 0xbdd2d3e8
    v_mov_b32 v5, 0xc0135761
    v_mov_b32 v6, 1.0
    v_mov_b32 v7, 1.0
    v_lshlrev_b32 v14, 4, v2
    s_lshl_b32 s46, s26, 2
    s_lshl_b32 s47, s38, 1
    s_add_u32 s46, s46, s47
    s_mul_i32 s46, s46, 112
    s_lshl_b32 s47, s27, 3
    s_add_u32 s46, s46, s47
    s_lshl_b32 s47, s39, 2
    s_add_u32 s46, s46, s47
    s_lshl_b32 s46, s46, 10
    s_add_u32 s46, s46, 0xc00000
    v_pk_mul_f32 v[16:17], v[64:65], v[64:65]
    v_pk_mul_f32 v[18:19], v[66:67], v[66:67]
    v_pk_mul_f32 v[20:21], v[68:69], v[68:69]
    v_pk_mul_f32 v[22:23], v[70:71], v[70:71]
    v_pk_mul_f32 v[24:25], v[72:73], v[72:73]
    v_pk_mul_f32 v[26:27], v[74:75], v[74:75]
    v_pk_mul_f32 v[28:29], v[76:77], v[76:77]
    v_pk_mul_f32 v[30:31], v[78:79], v[78:79]
    v_pk_fma_f32 v[16:17], v[16:17], v[4:5], v[4:5] op_sel:[0,0,1] op_sel_hi:[1,0,1]
    v_pk_fma_f32 v[18:19], v[18:19], v[4:5], v[4:5] op_sel:[0,0,1] op_sel_hi:[1,0,1]
    v_pk_fma_f32 v[20:21], v[20:21], v[4:5], v[4:5] op_sel:[0,0,1] op_sel_hi:[1,0,1]
    v_pk_fma_f32 v[22:23], v[22:23], v[4:5], v[4:5] op_sel:[0,0,1] op_sel_hi:[1,0,1]
    v_pk_fma_f32 v[24:25], v[24:25], v[4:5], v[4:5] op_sel:[0,0,1] op_sel_hi:[1,0,1]
    v_pk_fma_f32 v[26:27], v[26:27], v[4:5], v[4:5] op_sel:[0,0,1] op_sel_hi:[1,0,1]
    v_pk_fma_f32 v[28:29], v[28:29], v[4:5], v[4:5] op_sel:[0,0,1] op_sel_hi:[1,0,1]
    v_pk_fma_f32 v[30:31], v[30:31], v[4:5], v[4:5] op_sel:[0,0,1] op_sel_hi:[1,0,1]
    v_pk_mul_f32 v[16:17], v[16:17], v[64:65]
    v_pk_mul_f32 v[18:19], v[18:19], v[66:67]
    v_pk_mul_f32 v[20:21], v[20:21], v[68:69]
    v_pk_mul_f32 v[22:23], v[22:23], v[70:71]
    v_pk_mul_f32 v[24:25], v[24:25], v[72:73]
    v_pk_mul_f32 v[26:27], v[26:27], v[74:75]
    v_pk_mul_f32 v[28:29], v[28:29], v[76:77]
    v_pk_mul_f32 v[30:31], v[30:31], v[78:79]
    v_exp_f32 v16, v16
    v_exp_f32 v17, v17
    v_exp_f32 v18, v18
    v_exp_f32 v19, v19
    v_exp_f32 v20, v20
    v_exp_f32 v21, v21
    v_exp_f32 v22, v22
    v_exp_f32 v23, v23
    v_exp_f32 v24, v24
    v_exp_f32 v25, v25
    v_exp_f32 v26, v26
    v_exp_f32 v27, v27
    v_exp_f32 v28, v28
    v_exp_f32 v29, v29
    v_exp_f32 v30, v30
    v_exp_f32 v31, v31
    v_pk_add_f32 v[16:17], v[16:17], v[6:7]
    v_pk_add_f32 v[18:19], v[18:19], v[6:7]
    v_pk_add_f32 v[20:21], v[20:21], v[6:7]
    v_pk_add_f32 v[22:23], v[22:23], v[6:7]
    v_pk_add_f32 v[24:25], v[24:25], v[6:7]
    v_pk_add_f32 v[26:27], v[26:27], v[6:7]
    v_pk_add_f32 v[28:29], v[28:29], v[6:7]
    v_pk_add_f32 v[30:31], v[30:31], v[6:7]
    v_rcp_f32 v16, v16
    v_rcp_f32 v17, v17
    v_rcp_f32 v18, v18
    v_rcp_f32 v19, v19
    v_rcp_f32 v20, v20
    v_rcp_f32 v21, v21
    v_rcp_f32 v22, v22
    v_rcp_f32 v23, v23
    v_rcp_f32 v24, v24
    v_rcp_f32 v25, v25
    v_rcp_f32 v26, v26
    v_rcp_f32 v27, v27
    v_rcp_f32 v28, v28
    v_rcp_f32 v29, v29
    v_rcp_f32 v30, v30
    v_rcp_f32 v31, v31
    v_pk_mul_f32 v[64:65], v[64:65], v[16:17]
    v_pk_mul_f32 v[66:67], v[66:67], v[18:19]
    v_pk_mul_f32 v[68:69], v[68:69], v[20:21]
    v_pk_mul_f32 v[70:71], v[70:71], v[22:23]
    v_pk_mul_f32 v[72:73], v[72:73], v[24:25]
    v_pk_mul_f32 v[74:75], v[74:75], v[26:27]
    v_pk_mul_f32 v[76:77], v[76:77], v[28:29]
    v_pk_mul_f32 v[78:79], v[78:79], v[30:31]
    v_cvt_pk_bf16_f32 v128, v64, v65
    v_cvt_pk_bf16_f32 v129, v66, v67
    v_cvt_pk_bf16_f32 v130, v68, v69
    v_cvt_pk_bf16_f32 v131, v70, v71
    s_add_u32 s47, s46, 0
    buffer_store_dwordx4 v[128:131], v14, s[28:31], s47 offen
    v_cvt_pk_bf16_f32 v132, v72, v73
    v_cvt_pk_bf16_f32 v133, v74, v75
    v_cvt_pk_bf16_f32 v134, v76, v77
    v_cvt_pk_bf16_f32 v135, v78, v79
    s_add_u32 s47, s46, 1024
    buffer_store_dwordx4 v[132:135], v14, s[28:31], s47 offen
    v_pk_mul_f32 v[16:17], v[80:81], v[80:81]
    v_pk_mul_f32 v[18:19], v[82:83], v[82:83]
    v_pk_mul_f32 v[20:21], v[84:85], v[84:85]
    v_pk_mul_f32 v[22:23], v[86:87], v[86:87]
    v_pk_mul_f32 v[24:25], v[88:89], v[88:89]
    v_pk_mul_f32 v[26:27], v[90:91], v[90:91]
    v_pk_mul_f32 v[28:29], v[92:93], v[92:93]
    v_pk_mul_f32 v[30:31], v[94:95], v[94:95]
    v_pk_fma_f32 v[16:17], v[16:17], v[4:5], v[4:5] op_sel:[0,0,1] op_sel_hi:[1,0,1]
    v_pk_fma_f32 v[18:19], v[18:19], v[4:5], v[4:5] op_sel:[0,0,1] op_sel_hi:[1,0,1]
    v_pk_fma_f32 v[20:21], v[20:21], v[4:5], v[4:5] op_sel:[0,0,1] op_sel_hi:[1,0,1]
    v_pk_fma_f32 v[22:23], v[22:23], v[4:5], v[4:5] op_sel:[0,0,1] op_sel_hi:[1,0,1]
    v_pk_fma_f32 v[24:25], v[24:25], v[4:5], v[4:5] op_sel:[0,0,1] op_sel_hi:[1,0,1]
    v_pk_fma_f32 v[26:27], v[26:27], v[4:5], v[4:5] op_sel:[0,0,1] op_sel_hi:[1,0,1]
    v_pk_fma_f32 v[28:29], v[28:29], v[4:5], v[4:5] op_sel:[0,0,1] op_sel_hi:[1,0,1]
    v_pk_fma_f32 v[30:31], v[30:31], v[4:5], v[4:5] op_sel:[0,0,1] op_sel_hi:[1,0,1]
    v_pk_mul_f32 v[16:17], v[16:17], v[80:81]
    v_pk_mul_f32 v[18:19], v[18:19], v[82:83]
    v_pk_mul_f32 v[20:21], v[20:21], v[84:85]
    v_pk_mul_f32 v[22:23], v[22:23], v[86:87]
    v_pk_mul_f32 v[24:25], v[24:25], v[88:89]
    v_pk_mul_f32 v[26:27], v[26:27], v[90:91]
    v_pk_mul_f32 v[28:29], v[28:29], v[92:93]
    v_pk_mul_f32 v[30:31], v[30:31], v[94:95]
    v_exp_f32 v16, v16
    v_exp_f32 v17, v17
    v_exp_f32 v18, v18
    v_exp_f32 v19, v19
    v_exp_f32 v20, v20
    v_exp_f32 v21, v21
    v_exp_f32 v22, v22
    v_exp_f32 v23, v23
    v_exp_f32 v24, v24
    v_exp_f32 v25, v25
    v_exp_f32 v26, v26
    v_exp_f32 v27, v27
    v_exp_f32 v28, v28
    v_exp_f32 v29, v29
    v_exp_f32 v30, v30
    v_exp_f32 v31, v31
    v_pk_add_f32 v[16:17], v[16:17], v[6:7]
    v_pk_add_f32 v[18:19], v[18:19], v[6:7]
    v_pk_add_f32 v[20:21], v[20:21], v[6:7]
    v_pk_add_f32 v[22:23], v[22:23], v[6:7]
    v_pk_add_f32 v[24:25], v[24:25], v[6:7]
    v_pk_add_f32 v[26:27], v[26:27], v[6:7]
    v_pk_add_f32 v[28:29], v[28:29], v[6:7]
    v_pk_add_f32 v[30:31], v[30:31], v[6:7]
    v_rcp_f32 v16, v16
    v_rcp_f32 v17, v17
    v_rcp_f32 v18, v18
    v_rcp_f32 v19, v19
    v_rcp_f32 v20, v20
    v_rcp_f32 v21, v21
    v_rcp_f32 v22, v22
    v_rcp_f32 v23, v23
    v_rcp_f32 v24, v24
    v_rcp_f32 v25, v25
    v_rcp_f32 v26, v26
    v_rcp_f32 v27, v27
    v_rcp_f32 v28, v28
    v_rcp_f32 v29, v29
    v_rcp_f32 v30, v30
    v_rcp_f32 v31, v31
    v_pk_mul_f32 v[80:81], v[80:81], v[16:17]
    v_pk_mul_f32 v[82:83], v[82:83], v[18:19]
    v_pk_mul_f32 v[84:85], v[84:85], v[20:21]
    v_pk_mul_f32 v[86:87], v[86:87], v[22:23]
    v_pk_mul_f32 v[88:89], v[88:89], v[24:25]
    v_pk_mul_f32 v[90:91], v[90:91], v[26:27]
    v_pk_mul_f32 v[92:93], v[92:93], v[28:29]
    v_pk_mul_f32 v[94:95], v[94:95], v[30:31]
    v_cvt_pk_bf16_f32 v136, v80, v81
    v_cvt_pk_bf16_f32 v137, v82, v83
    v_cvt_pk_bf16_f32 v138, v84, v85
    v_cvt_pk_bf16_f32 v139, v86, v87
    s_add_u32 s47, s46, 2048
    buffer_store_dwordx4 v[136:139], v14, s[28:31], s47 offen
    v_cvt_pk_bf16_f32 v140, v88, v89
    v_cvt_pk_bf16_f32 v141, v90, v91
    v_cvt_pk_bf16_f32 v142, v92, v93
    v_cvt_pk_bf16_f32 v143, v94, v95
    s_add_u32 s47, s46, 3072
    buffer_store_dwordx4 v[140:143], v14, s[28:31], s47 offen
    v_pk_mul_f32 v[16:17], v[96:97], v[96:97]
    v_pk_mul_f32 v[18:19], v[98:99], v[98:99]
    v_pk_mul_f32 v[20:21], v[100:101], v[100:101]
    v_pk_mul_f32 v[22:23], v[102:103], v[102:103]
    v_pk_mul_f32 v[24:25], v[104:105], v[104:105]
    v_pk_mul_f32 v[26:27], v[106:107], v[106:107]
    v_pk_mul_f32 v[28:29], v[108:109], v[108:109]
    v_pk_mul_f32 v[30:31], v[110:111], v[110:111]
    v_pk_fma_f32 v[16:17], v[16:17], v[4:5], v[4:5] op_sel:[0,0,1] op_sel_hi:[1,0,1]
    v_pk_fma_f32 v[18:19], v[18:19], v[4:5], v[4:5] op_sel:[0,0,1] op_sel_hi:[1,0,1]
    v_pk_fma_f32 v[20:21], v[20:21], v[4:5], v[4:5] op_sel:[0,0,1] op_sel_hi:[1,0,1]
    v_pk_fma_f32 v[22:23], v[22:23], v[4:5], v[4:5] op_sel:[0,0,1] op_sel_hi:[1,0,1]
    v_pk_fma_f32 v[24:25], v[24:25], v[4:5], v[4:5] op_sel:[0,0,1] op_sel_hi:[1,0,1]
    v_pk_fma_f32 v[26:27], v[26:27], v[4:5], v[4:5] op_sel:[0,0,1] op_sel_hi:[1,0,1]
    v_pk_fma_f32 v[28:29], v[28:29], v[4:5], v[4:5] op_sel:[0,0,1] op_sel_hi:[1,0,1]
    v_pk_fma_f32 v[30:31], v[30:31], v[4:5], v[4:5] op_sel:[0,0,1] op_sel_hi:[1,0,1]
    v_pk_mul_f32 v[16:17], v[16:17], v[96:97]
    v_pk_mul_f32 v[18:19], v[18:19], v[98:99]
    v_pk_mul_f32 v[20:21], v[20:21], v[100:101]
    v_pk_mul_f32 v[22:23], v[22:23], v[102:103]
    v_pk_mul_f32 v[24:25], v[24:25], v[104:105]
    v_pk_mul_f32 v[26:27], v[26:27], v[106:107]
    v_pk_mul_f32 v[28:29], v[28:29], v[108:109]
    v_pk_mul_f32 v[30:31], v[30:31], v[110:111]
    v_exp_f32 v16, v16
    v_exp_f32 v17, v17
    v_exp_f32 v18, v18
    v_exp_f32 v19, v19
    v_exp_f32 v20, v20
    v_exp_f32 v21, v21
    v_exp_f32 v22, v22
    v_exp_f32 v23, v23
    v_exp_f32 v24, v24
    v_exp_f32 v25, v25
    v_exp_f32 v26, v26
    v_exp_f32 v27, v27
    v_exp_f32 v28, v28
    v_exp_f32 v29, v29
    v_exp_f32 v30, v30
    v_exp_f32 v31, v31
    v_pk_add_f32 v[16:17], v[16:17], v[6:7]
    v_pk_add_f32 v[18:19], v[18:19], v[6:7]
    v_pk_add_f32 v[20:21], v[20:21], v[6:7]
    v_pk_add_f32 v[22:23], v[22:23], v[6:7]
    v_pk_add_f32 v[24:25], v[24:25], v[6:7]
    v_pk_add_f32 v[26:27], v[26:27], v[6:7]
    v_pk_add_f32 v[28:29], v[28:29], v[6:7]
    v_pk_add_f32 v[30:31], v[30:31], v[6:7]
    v_rcp_f32 v16, v16
    v_rcp_f32 v17, v17
    v_rcp_f32 v18, v18
    v_rcp_f32 v19, v19
    v_rcp_f32 v20, v20
    v_rcp_f32 v21, v21
    v_rcp_f32 v22, v22
    v_rcp_f32 v23, v23
    v_rcp_f32 v24, v24
    v_rcp_f32 v25, v25
    v_rcp_f32 v26, v26
    v_rcp_f32 v27, v27
    v_rcp_f32 v28, v28
    v_rcp_f32 v29, v29
    v_rcp_f32 v30, v30
    v_rcp_f32 v31, v31
    v_pk_mul_f32 v[96:97], v[96:97], v[16:17]
    v_pk_mul_f32 v[98:99], v[98:99], v[18:19]
    v_pk_mul_f32 v[100:101], v[100:101], v[20:21]
    v_pk_mul_f32 v[102:103], v[102:103], v[22:23]
    v_pk_mul_f32 v[104:105], v[104:105], v[24:25]
    v_pk_mul_f32 v[106:107], v[106:107], v[26:27]
    v_pk_mul_f32 v[108:109], v[108:109], v[28:29]
    v_pk_mul_f32 v[110:111], v[110:111], v[30:31]
    v_cvt_pk_bf16_f32 v128, v96, v97
    v_cvt_pk_bf16_f32 v129, v98, v99
    v_cvt_pk_bf16_f32 v130, v100, v101
    v_cvt_pk_bf16_f32 v131, v102, v103
    s_add_u32 s47, s46, 114688
    buffer_store_dwordx4 v[128:131], v14, s[28:31], s47 offen
    v_cvt_pk_bf16_f32 v132, v104, v105
    v_cvt_pk_bf16_f32 v133, v106, v107
    v_cvt_pk_bf16_f32 v134, v108, v109
    v_cvt_pk_bf16_f32 v135, v110, v111
    s_add_u32 s47, s46, 115712
    buffer_store_dwordx4 v[132:135], v14, s[28:31], s47 offen
    v_pk_mul_f32 v[16:17], v[112:113], v[112:113]
    v_pk_mul_f32 v[18:19], v[114:115], v[114:115]
    v_pk_mul_f32 v[20:21], v[116:117], v[116:117]
    v_pk_mul_f32 v[22:23], v[118:119], v[118:119]
    v_pk_mul_f32 v[24:25], v[120:121], v[120:121]
    v_pk_mul_f32 v[26:27], v[122:123], v[122:123]
    v_pk_mul_f32 v[28:29], v[124:125], v[124:125]
    v_pk_mul_f32 v[30:31], v[126:127], v[126:127]
    v_pk_fma_f32 v[16:17], v[16:17], v[4:5], v[4:5] op_sel:[0,0,1] op_sel_hi:[1,0,1]
    v_pk_fma_f32 v[18:19], v[18:19], v[4:5], v[4:5] op_sel:[0,0,1] op_sel_hi:[1,0,1]
    v_pk_fma_f32 v[20:21], v[20:21], v[4:5], v[4:5] op_sel:[0,0,1] op_sel_hi:[1,0,1]
    v_pk_fma_f32 v[22:23], v[22:23], v[4:5], v[4:5] op_sel:[0,0,1] op_sel_hi:[1,0,1]
    v_pk_fma_f32 v[24:25], v[24:25], v[4:5], v[4:5] op_sel:[0,0,1] op_sel_hi:[1,0,1]
    v_pk_fma_f32 v[26:27], v[26:27], v[4:5], v[4:5] op_sel:[0,0,1] op_sel_hi:[1,0,1]
    v_pk_fma_f32 v[28:29], v[28:29], v[4:5], v[4:5] op_sel:[0,0,1] op_sel_hi:[1,0,1]
    v_pk_fma_f32 v[30:31], v[30:31], v[4:5], v[4:5] op_sel:[0,0,1] op_sel_hi:[1,0,1]
    v_pk_mul_f32 v[16:17], v[16:17], v[112:113]
    v_pk_mul_f32 v[18:19], v[18:19], v[114:115]
    v_pk_mul_f32 v[20:21], v[20:21], v[116:117]
    v_pk_mul_f32 v[22:23], v[22:23], v[118:119]
    v_pk_mul_f32 v[24:25], v[24:25], v[120:121]
    v_pk_mul_f32 v[26:27], v[26:27], v[122:123]
    v_pk_mul_f32 v[28:29], v[28:29], v[124:125]
    v_pk_mul_f32 v[30:31], v[30:31], v[126:127]
    v_exp_f32 v16, v16
    v_exp_f32 v17, v17
    v_exp_f32 v18, v18
    v_exp_f32 v19, v19
    v_exp_f32 v20, v20
    v_exp_f32 v21, v21
    v_exp_f32 v22, v22
    v_exp_f32 v23, v23
    v_exp_f32 v24, v24
    v_exp_f32 v25, v25
    v_exp_f32 v26, v26
    v_exp_f32 v27, v27
    v_exp_f32 v28, v28
    v_exp_f32 v29, v29
    v_exp_f32 v30, v30
    v_exp_f32 v31, v31
    v_pk_add_f32 v[16:17], v[16:17], v[6:7]
    v_pk_add_f32 v[18:19], v[18:19], v[6:7]
    v_pk_add_f32 v[20:21], v[20:21], v[6:7]
    v_pk_add_f32 v[22:23], v[22:23], v[6:7]
    v_pk_add_f32 v[24:25], v[24:25], v[6:7]
    v_pk_add_f32 v[26:27], v[26:27], v[6:7]
    v_pk_add_f32 v[28:29], v[28:29], v[6:7]
    v_pk_add_f32 v[30:31], v[30:31], v[6:7]
    v_rcp_f32 v16, v16
    v_rcp_f32 v17, v17
    v_rcp_f32 v18, v18
    v_rcp_f32 v19, v19
    v_rcp_f32 v20, v20
    v_rcp_f32 v21, v21
    v_rcp_f32 v22, v22
    v_rcp_f32 v23, v23
    v_rcp_f32 v24, v24
    v_rcp_f32 v25, v25
    v_rcp_f32 v26, v26
    v_rcp_f32 v27, v27
    v_rcp_f32 v28, v28
    v_rcp_f32 v29, v29
    v_rcp_f32 v30, v30
    v_rcp_f32 v31, v31
    v_pk_mul_f32 v[112:113], v[112:113], v[16:17]
    v_pk_mul_f32 v[114:115], v[114:115], v[18:19]
    v_pk_mul_f32 v[116:117], v[116:117], v[20:21]
    v_pk_mul_f32 v[118:119], v[118:119], v[22:23]
    v_pk_mul_f32 v[120:121], v[120:121], v[24:25]
    v_pk_mul_f32 v[122:123], v[122:123], v[26:27]
    v_pk_mul_f32 v[124:125], v[124:125], v[28:29]
    v_pk_mul_f32 v[126:127], v[126:127], v[30:31]
    v_cvt_pk_bf16_f32 v136, v112, v113
    v_cvt_pk_bf16_f32 v137, v114, v115
    v_cvt_pk_bf16_f32 v138, v116, v117
    v_cvt_pk_bf16_f32 v139, v118, v119
    s_add_u32 s47, s46, 116736
    buffer_store_dwordx4 v[136:139], v14, s[28:31], s47 offen
    v_cvt_pk_bf16_f32 v140, v120, v121
    v_cvt_pk_bf16_f32 v141, v122, v123
    v_cvt_pk_bf16_f32 v142, v124, v125
    v_cvt_pk_bf16_f32 v143, v126, v127
    s_add_u32 s47, s46, 117760
    buffer_store_dwordx4 v[140:143], v14, s[28:31], s47 offen
    s_endpgm
kC_loader:
    s_cmp_ge_u32 s25, 28
    s_cbranch_scc1 kC_idle
    s_sub_u32 s38, s33, 4
    v_and_b32 v4, 63, v0
    v_lshlrev_b32 v8, 4, v4
    v_lshrrev_b32 v6, 4, v4
    v_lshlrev_b32 v5, 2, v6
    v_and_b32 v10, 15, v4
    v_xor_b32 v10, v10, v5
    v_lshlrev_b32 v10, 4, v10
    v_mul_lo_u32 v6, v6, s34
    v_add_u32 v10, v10, v6
    s_lshl_b32 s40, s26, 2
    s_add_u32 s40, s40, s38
    s_lshl_b32 s40, s40, 15
    s_add_u32 s40, s40, 0x800000
    s_lshl_b32 s41, s38, 4
    s_mul_i32 s41, s41, s34
    s_add_u32 s41, s41, s35
    s_lshl_b32 s42, s34, 2
    s_lshl_b32 s43, s34, 6
    s_lshl_b32 s44, s38, 12
    s_lshl_b32 s45, s38, 12
    s_mul_i32 s47, s37, 4096
    s_add_u32 s47, s47, s40
    s_mul_i32 s48, s37, s43
    s_add_u32 s48, s48, s41
    s_add_u32 m0, s44, 0
    s_nop 0
    buffer_load_dwordx4 v8, s[28:31], s47 offen offset:0 lds
    buffer_load_dwordx4 v8, s[28:31], s47 offen offset:1024 lds
    buffer_load_dwordx4 v8, s[28:31], s47 offen offset:2048 lds
    buffer_load_dwordx4 v8, s[28:31], s47 offen offset:3072 lds
    s_add_u32 m0, s45, 16384
    s_mov_b32 s46, s48
    buffer_load_dwordx4 v10, s[12:15], s46 offen lds
    s_add_u32 m0, m0, 1024
    s_add_u32 s46, s46, s42
    buffer_load_dwordx4 v10, s[12:15], s46 offen lds
    s_add_u32 m0, m0, 1024
    s_add_u32 s46, s46, s42
    buffer_load_dwordx4 v10, s[12:15], s46 offen lds
    s_add_u32 m0, m0, 1024
    s_add_u32 s46, s46, s42
    buffer_load_dwordx4 v10, s[12:15], s46 offen lds
    s_add_u32 s37, s37, 1
    s_and_b32 s37, s37, 7
    s_mul_i32 s47, s37, 4096
    s_add_u32 s47, s47, s40
    s_mul_i32 s48, s37, s43
    s_add_u32 s48, s48, s41
    s_add_u32 m0, s44, 32768
    s_nop 0
    buffer_load_dwordx4 v8, s[28:31], s47 offen offset:0 lds
    buffer_load_dwordx4 v8, s[28:31], s47 offen offset:1024 lds
    buffer_load_dwordx4 v8, s[28:31], s47 offen offset:2048 lds
    buffer_load_dwordx4 v8, s[28:31], s47 offen offset:3072 lds
    s_add_u32 m0, s45, 49152
    s_mov_b32 s46, s48
    buffer_load_dwordx4 v10, s[12:15], s46 offen lds
    s_add_u32 m0, m0, 1024
    s_add_u32 s46, s46, s42
    buffer_load_dwordx4 v10, s[12:15], s46 offen lds
    s_add_u32 m0, m0, 1024
    s_add_u32 s46, s46, s42
    buffer_load_dwordx4 v10, s[12:15], s46 offen lds
    s_add_u32 m0, m0, 1024
    s_add_u32 s46, s46, s42
    buffer_load_dwordx4 v10, s[12:15], s46 offen lds
    s_add_u32 s37, s37, 1
    s_and_b32 s37, s37, 7
    s_waitcnt vmcnt(8)
    s_barrier
    s_mul_i32 s47, s37, 4096
    s_add_u32 s47, s47, s40
    s_mul_i32 s48, s37, s43
    s_add_u32 s48, s48, s41
    s_add_u32 m0, s44, 65536
    s_nop 0
    buffer_load_dwordx4 v8, s[28:31], s47 offen offset:0 lds
    buffer_load_dwordx4 v8, s[28:31], s47 offen offset:1024 lds
    buffer_load_dwordx4 v8, s[28:31], s47 offen offset:2048 lds
    buffer_load_dwordx4 v8, s[28:31], s47 offen offset:3072 lds
    s_add_u32 m0, s45, 81920
    s_mov_b32 s46, s48
    buffer_load_dwordx4 v10, s[12:15], s46 offen lds
    s_add_u32 m0, m0, 1024
    s_add_u32 s46, s46, s42
    buffer_load_dwordx4 v10, s[12:15], s46 offen lds
    s_add_u32 m0, m0, 1024
    s_add_u32 s46, s46, s42
    buffer_load_dwordx4 v10, s[12:15], s46 offen lds
    s_add_u32 m0, m0, 1024
    s_add_u32 s46, s46, s42
    buffer_load_dwordx4 v10, s[12:15], s46 offen lds
    s_add_u32 s37, s37, 1
    s_and_b32 s37, s37, 7
    s_mul_i32 s47, s37, 4096
    s_add_u32 s47, s47, s40
    s_mul_i32 s48, s37, s43
    s_add_u32 s48, s48, s41
    s_add_u32 m0, s44, 98304
    s_nop 0
    buffer_load_dwordx4 v8, s[28:31], s47 offen offset:0 lds
    buffer_load_dwordx4 v8, s[28:31], s47 offen offset:1024 lds
    buffer_load_dwordx4 v8, s[28:31], s47 offen offset:2048 lds
    buffer_load_dwordx4 v8, s[28:31], s47 offen offset:3072 lds
    s_add_u32 m0, s45, 114688
    s_mov_b32 s46, s48
    buffer_load_dwordx4 v10, s[12:15], s46 offen lds
    s_add_u32 m0, m0, 1024
    s_add_u32 s46, s46, s42
    buffer_load_dwordx4 v10, s[12:15], s46 offen lds
    s_add_u32 m0, m0, 1024
    s_add_u32 s46, s46, s42
    buffer_load_dwordx4 v10, s[12:15], s46 offen lds
    s_add_u32 m0, m0, 1024
    s_add_u32 s46, s46, s42
    buffer_load_dwordx4 v10, s[12:15], s46 offen lds
    s_add_u32 s37, s37, 1
    s_and_b32 s37, s37, 7
    s_waitcnt vmcnt(16)
    s_barrier
    s_mul_i32 s47, s37, 4096
    s_add_u32 s47, s47, s40
    s_mul_i32 s48, s37, s43
    s_add_u32 s48, s48, s41
    s_add_u32 m0, s44, 0
    s_nop 0
    buffer_load_dwordx4 v8, s[28:31], s47 offen offset:0 lds
    buffer_load_dwordx4 v8, s[28:31], s47 offen offset:1024 lds
    buffer_load_dwordx4 v8, s[28:31], s47 offen offset:2048 lds
    buffer_load_dwordx4 v8, s[28:31], s47 offen offset:3072 lds
    s_add_u32 m0, s45, 16384
    s_mov_b32 s46, s48
    buffer_load_dwordx4 v10, s[12:15], s46 offen lds
    s_add_u32 m0, m0, 1024
    s_add_u32 s46, s46, s42
    buffer_load_dwordx4 v10, s[12:15], s46 offen lds
    s_add_u32 m0, m0, 1024
    s_add_u32 s46, s46, s42
    buffer_load_dwordx4 v10, s[12:15], s46 offen lds
    s_add_u32 m0, m0, 1024
    s_add_u32 s46, s46, s42
    buffer_load_dwordx4 v10, s[12:15], s46 offen lds
    s_add_u32 s37, s37, 1
    s_and_b32 s37, s37, 7
    s_waitcnt vmcnt(16)
    s_barrier
    s_mul_i32 s47, s37, 4096
    s_add_u32 s47, s47, s40
    s_mul_i32 s48, s37, s43
    s_add_u32 s48, s48, s41
    s_add_u32 m0, s44, 32768
    s_nop 0
    buffer_load_dwordx4 v8, s[28:31], s47 offen offset:0 lds
    buffer_load_dwordx4 v8, s[28:31], s47 offen offset:1024 lds
    buffer_load_dwordx4 v8, s[28:31], s47 offen offset:2048 lds
    buffer_load_dwordx4 v8, s[28:31], s47 offen offset:3072 lds
    s_add_u32 m0, s45, 49152
    s_mov_b32 s46, s48
    buffer_load_dwordx4 v10, s[12:15], s46 offen lds
    s_add_u32 m0, m0, 1024
    s_add_u32 s46, s46, s42
    buffer_load_dwordx4 v10, s[12:15], s46 offen lds
    s_add_u32 m0, m0, 1024
    s_add_u32 s46, s46, s42
    buffer_load_dwordx4 v10, s[12:15], s46 offen lds
    s_add_u32 m0, m0, 1024
    s_add_u32 s46, s46, s42
    buffer_load_dwordx4 v10, s[12:15], s46 offen lds
    s_add_u32 s37, s37, 1
    s_and_b32 s37, s37, 7
    s_waitcnt vmcnt(16)
    s_barrier
    s_mul_i32 s47, s37, 4096
    s_add_u32 s47, s47, s40
    s_mul_i32 s48, s37, s43
    s_add_u32 s48, s48, s41
    s_add_u32 m0, s44, 65536
    s_nop 0
    buffer_load_dwordx4 v8, s[28:31], s47 offen offset:0 lds
    buffer_load_dwordx4 v8, s[28:31], s47 offen offset:1024 lds
    buffer_load_dwordx4 v8, s[28:31], s47 offen offset:2048 lds
    buffer_load_dwordx4 v8, s[28:31], s47 offen offset:3072 lds
    s_add_u32 m0, s45, 81920
    s_mov_b32 s46, s48
    buffer_load_dwordx4 v10, s[12:15], s46 offen lds
    s_add_u32 m0, m0, 1024
    s_add_u32 s46, s46, s42
    buffer_load_dwordx4 v10, s[12:15], s46 offen lds
    s_add_u32 m0, m0, 1024
    s_add_u32 s46, s46, s42
    buffer_load_dwordx4 v10, s[12:15], s46 offen lds
    s_add_u32 m0, m0, 1024
    s_add_u32 s46, s46, s42
    buffer_load_dwordx4 v10, s[12:15], s46 offen lds
    s_add_u32 s37, s37, 1
    s_and_b32 s37, s37, 7
    s_waitcnt vmcnt(16)
    s_barrier
    s_mul_i32 s47, s37, 4096
    s_add_u32 s47, s47, s40
    s_mul_i32 s48, s37, s43
    s_add_u32 s48, s48, s41
    s_add_u32 m0, s44, 98304
    s_nop 0
    buffer_load_dwordx4 v8, s[28:31], s47 offen offset:0 lds
    buffer_load_dwordx4 v8, s[28:31], s47 offen offset:1024 lds
    buffer_load_dwordx4 v8, s[28:31], s47 offen offset:2048 lds
    buffer_load_dwordx4 v8, s[28:31], s47 offen offset:3072 lds
    s_add_u32 m0, s45, 114688
    s_mov_b32 s46, s48
    buffer_load_dwordx4 v10, s[12:15], s46 offen lds
    s_add_u32 m0, m0, 1024
    s_add_u32 s46, s46, s42
    buffer_load_dwordx4 v10, s[12:15], s46 offen lds
    s_add_u32 m0, m0, 1024
    s_add_u32 s46, s46, s42
    buffer_load_dwordx4 v10, s[12:15], s46 offen lds
    s_add_u32 m0, m0, 1024
    s_add_u32 s46, s46, s42
    buffer_load_dwordx4 v10, s[12:15], s46 offen lds
    s_waitcnt vmcnt(16)
    s_barrier
    s_waitcnt vmcnt(8)
    s_barrier
    s_waitcnt vmcnt(0)
    s_barrier
    s_endpgm
ld_40:
kC_idle:
    s_mov_b32 s52, s6
    s_mov_b32 s53, s7
    s_mov_b32 s54, 0x1c0000
    s_mov_b32 s55, 0x20000
    s_sub_u32 s50, s25, 28
    s_lshl_b32 s51, s24, 2
    s_add_u32 s50, s50, s51
    s_lshl_b32 s50, s50, 3
    s_add_u32 s50, s50, s33
    s_lshl_b32 s56, s33, 13
    v_bfe_u32 v4, v2, 4, 1
    v_lshlrev_b32 v4, 2, v4
    v_and_b32 v5, 7, v2
    v_xor_b32 v4, v4, v5
    v_lshlrev_b32 v4, 4, v4
    v_lshrrev_b32 v5, 3, v2
    v_mul_u32_u24 v5, 1024, v5
    v_add_u32 v6, v5, v4
    v_bfe_u32 v4, v2, 4, 1
    v_lshlrev_b32 v4, 1, v4
    v_bfe_u32 v5, v2, 1, 1
    v_add_u32 v4, v4, v5
    v_bfe_u32 v5, v2, 3, 1
    v_lshlrev_b32 v5, 2, v5
    v_xor_b32 v4, v4, v5
    v_lshlrev_b32 v4, 4, v4
    v_and_b32 v5, 1, v2
    v_lshl_add_u32 v4, v5, 3, v4
    v_add_u32 v4, s56, v4
    v_lshrrev_b32 v5, 5, v2
    v_lshlrev_b32 v5, 2, v5
    v_bfe_u32 v8, v2, 2, 2
    v_add_u32 v5, v5, v8
    v_lshl_add_u32 v7, v5, 7, v4
    v_xor_b32 v8, 64, v7
    v_lshlrev_b32 v4, 4, v2
    s_add_u32 s57, s50, 0
    s_min_u32 s57, s57, 895
    s_mul_i32 s58, s57, 37450
    s_lshr_b32 s58, s58, 22
    s_mul_i32 s59, s58, 112
    s_sub_u32 s59, s57, s59
    s_lshl_b32 s60, s59, 14
    s_lshl_b32 s61, s58, 7
    s_add_u32 s60, s60, s61
    s_add_u32 m0, s56, 0
    s_add_u32 s61, s60, 8192
    buffer_load_dwordx4 v6, s[52:55], s60 offen lds
    s_add_u32 m0, m0, 1024
    s_nop 0
    buffer_load_dwordx4 v6, s[52:55], s61 offen lds
    s_lshl_b32 s40, s58, 1
    s_mul_i32 s40, s40, 112
    s_add_u32 s40, s40, s59
    s_lshl_b32 s40, s40, 10
    s_add_u32 s40, s40, 0x1800000
    s_add_u32 s41, s40, 114688
    s_add_u32 s57, s50, 256
    s_min_u32 s57, s57, 895
    s_mul_i32 s58, s57, 37450
    s_lshr_b32 s58, s58, 22
    s_mul_i32 s59, s58, 112
    s_sub_u32 s59, s57, s59
    s_lshl_b32 s60, s59, 14
    s_lshl_b32 s61, s58, 7
    s_add_u32 s60, s60, s61
    s_add_u32 m0, s56, 2048
    s_add_u32 s61, s60, 8192
    buffer_load_dwordx4 v6, s[52:55], s60 offen lds
    s_add_u32 m0, m0, 1024
    s_nop 0
    buffer_load_dwordx4 v6, s[52:55], s61 offen lds
    s_lshl_b32 s42, s58, 1
    s_mul_i32 s42, s42, 112
    s_add_u32 s42, s42, s59
    s_lshl_b32 s42, s42, 10
    s_add_u32 s42, s42, 0x1800000
    s_add_u32 s43, s42, 114688
    s_add_u32 s57, s50, 512
    s_min_u32 s57, s57, 895
    s_mul_i32 s58, s57, 37450
    s_lshr_b32 s58, s58, 22
    s_mul_i32 s59, s58, 112
    s_sub_u32 s59, s57, s59
    s_lshl_b32 s60, s59, 14
    s_lshl_b32 s61, s58, 7
    s_add_u32 s60, s60, s61
    s_add_u32 m0, s56, 4096
    s_add_u32 s61, s60, 8192
    buffer_load_dwordx4 v6, s[52:55], s60 offen lds
    s_add_u32 m0, m0, 1024
    s_nop 0
    buffer_load_dwordx4 v6, s[52:55], s61 offen lds
    s_lshl_b32 s44, s58, 1
    s_mul_i32 s44, s44, 112
    s_add_u32 s44, s44, s59
    s_lshl_b32 s44, s44, 10
    s_add_u32 s44, s44, 0x1800000
    s_add_u32 s45, s44, 114688
    s_add_u32 s57, s50, 768
    s_min_u32 s57, s57, 895
    s_mul_i32 s58, s57, 37450
    s_lshr_b32 s58, s58, 22
    s_mul_i32 s59, s58, 112
    s_sub_u32 s59, s57, s59
    s_lshl_b32 s60, s59, 14
    s_lshl_b32 s61, s58, 7
    s_add_u32 s60, s60, s61
    s_add_u32 m0, s56, 6144
    s_add_u32 s61, s60, 8192
    buffer_load_dwordx4 v6, s[52:55], s60 offen lds
    s_add_u32 m0, m0, 1024
    s_nop 0
    buffer_load_dwordx4 v6, s[52:55], s61 offen lds
    s_lshl_b32 s46, s58, 1
    s_mul_i32 s46, s46, 112
    s_add_u32 s46, s46, s59
    s_lshl_b32 s46, s46, 10
    s_add_u32 s46, s46, 0x1800000
    s_add_u32 s47, s46, 114688
    s_waitcnt vmcnt(6)
    ds_read_b64_tr_b16 v[16:17], v7 offset:0
    ds_read_b64_tr_b16 v[18:19], v7 offset:1024
    ds_read_b64_tr_b16 v[20:21], v8 offset:0
    ds_read_b64_tr_b16 v[22:23], v8 offset:1024
    s_waitcnt lgkmcnt(0)
    buffer_store_dwordx4 v[16:19], v4, s[28:31], s40 offen
    buffer_store_dwordx4 v[20:23], v4, s[28:31], s41 offen
    s_waitcnt vmcnt(6)
    ds_read_b64_tr_b16 v[24:25], v7 offset:2048
    ds_read_b64_tr_b16 v[26:27], v7 offset:3072
    ds_read_b64_tr_b16 v[28:29], v8 offset:2048
    ds_read_b64_tr_b16 v[30:31], v8 offset:3072
    s_waitcnt lgkmcnt(0)
    buffer_store_dwordx4 v[24:27], v4, s[28:31], s42 offen
    buffer_store_dwordx4 v[28:31], v4, s[28:31], s43 offen
    s_waitcnt vmcnt(6)
    ds_read_b64_tr_b16 v[32:33], v7 offset:4096
    ds_read_b64_tr_b16 v[34:35], v7 offset:5120
    ds_read_b64_tr_b16 v[36:37], v8 offset:4096
    ds_read_b64_tr_b16 v[38:39], v8 offset:5120
    s_waitcnt lgkmcnt(0)
    buffer_store_dwordx4 v[32:35], v4, s[28:31], s44 offen
    buffer_store_dwordx4 v[36:39], v4, s[28:31], s45 offen
    s_waitcnt vmcnt(6)
    ds_read_b64_tr_b16 v[40:41], v7 offset:6144
    ds_read_b64_tr_b16 v[42:43], v7 offset:7168
    ds_read_b64_tr_b16 v[44:45], v8 offset:6144
    ds_read_b64_tr_b16 v[46:47], v8 offset:7168
    s_waitcnt lgkmcnt(0)
    buffer_store_dwordx4 v[40:43], v4, s[28:31], s46 offen
    buffer_store_dwordx4 v[44:47], v4, s[28:31], s47 offen
kC_done:
    s_endpgm
.globl kD_kernel
.p2align 8
.type kD_kernel,@function
kD_kernel:
    s_cmp_ge_u32 s2, 256
    s_cbranch_scc1 kD_done
    s_load_dwordx2 s[4:5], s[0:1], 0
    s_load_dwordx2 s[18:19], s[0:1], 64
    s_load_dwordx2 s[22:23], s[0:1], 80
    v_lshrrev_b32 v1, 6, v0
    v_and_b32 v2, 63, v0
    v_readfirstlane_b32 s33, v1
    s_and_b32 s24, s2, 7
    s_lshr_b32 s25, s2, 3
    s_lshr_b32 s26, s25, 3
    s_lshl_b32 s27, s24, 2
    s_add_u32 s26, s26, s27
    s_and_b32 s27, s25, 7
    s_mul_i32 s35, s33, 28
    s_lshl_b32 s36, s33, 3
    v_lshlrev_b32 v4, 4, v2
    s_waitcnt lgkmcnt(0)
    s_mov_b32 s28, s22
    s_mov_b32 s29, s23
    s_mov_b32 s30, 0x10000000
    s_mov_b32 s31, 0x20000
    s_mov_b32 s8, s4
    s_mov_b32 s9, s5
    s_mov_b32 s10, 0x200000
    s_mov_b32 s11, 0x20000
    s_mov_b32 s44, s18
    s_mov_b32 s45, s19
    s_mov_b32 s46, 0x200000
    s_mov_b32 s47, 0x20000
    s_mov_b32 s38, 0
    s_mov_b32 s39, 0
    s_lshl_b32 s50, s26, 1
    s_mul_i32 s50, s50, 32
    s_add_u32 s50, s50, s36
    s_lshl_b32 s50, s50, 10
    s_add_u32 s50, s50, 0xa00000
    s_add_u32 s51, s50, 0x8000
    s_lshl_b32 s52, s27, 1
    s_mul_i32 s52, s52, 32
    s_add_u32 s52, s52, s36
    s_lshl_b32 s52, s52, 10
    s_add_u32 s52, s52, 0x1780000
    s_add_u32 s53, s52, 0x8000
    s_lshl_b32 s55, s38, 10
    v_add_u32 v5, s55, v4
    buffer_load_dwordx4 v[24:27], v5, s[28:31], s52 offen
    buffer_load_dwordx4 v[16:19], v5, s[28:31], s50 offen
    buffer_load_dwordx4 v[20:23], v5, s[28:31], s51 offen
    buffer_load_dwordx4 v[28:31], v5, s[28:31], s53 offen
    s_add_u32 s55, s55, 1024
    s_cmp_eq_u32 s55, 8192
    s_cselect_b32 s55, 0, s55
    v_add_u32 v5, s55, v4
    buffer_load_dwordx4 v[40:43], v5, s[28:31], s52 offen
    buffer_load_dwordx4 v[32:35], v5, s[28:31], s50 offen
    buffer_load_dwordx4 v[36:39], v5, s[28:31], s51 offen
    buffer_load_dwordx4 v[44:47], v5, s[28:31], s53 offen
    s_add_u32 s55, s55, 1024
    s_cmp_eq_u32 s55, 8192
    s_cselect_b32 s55, 0, s55
    v_add_u32 v5, s55, v4
    buffer_load_dwordx4 v[56:59], v5, s[28:31], s52 offen
    buffer_load_dwordx4 v[48:51], v5, s[28:31], s50 offen
    buffer_load_dwordx4 v[52:55], v5, s[28:31], s51 offen
    buffer_load_dwordx4 v[60:63], v5, s[28:31], s53 offen
    s_lshr_b32 s60, s33, 1
    s_and_b32 s61, s33, 1
    s_lshl_b32 s62, s26, 6
    s_lshl_b32 s63, s60, 5
    s_add_u32 s62, s62, s63
    s_lshl_b32 s63, s27, 6
    s_lshl_b32 s64, s61, 5
    s_add_u32 s63, s63, s64
    v_and_b32 v12, 31, v2
    v_lshrrev_b32 v13, 5, v2
    v_lshlrev_b32 v14, 10, v12
    v_lshl_add_u32 v14, v13, 3, v14
    s_lshl_b32 s64, s62, 10
    s_lshl_b32 s65, s63, 1
    s_add_u32 s64, s64, s65
    buffer_load_dwordx2 v[112:113], v14, s[8:11], s64 offen offset:0
    buffer_load_dwordx2 v[114:115], v14, s[8:11], s64 offen offset:16
    buffer_load_dwordx2 v[116:117], v14, s[8:11], s64 offen offset:32
    buffer_load_dwordx2 v[118:119], v14, s[8:11], s64 offen offset:48
    s_lshl_b32 s59, s26, 1
    s_add_u32 s59, s59, s60
    s_lshl_b32 s59, s59, 5
    s_lshl_b32 s65, s27, 2
    s_add_u32 s59, s59, s65
    s_lshl_b32 s65, s61, 1
    s_add_u32 s59, s59, s65
    s_lshl_b32 s59, s59, 10
    s_add_u32 s59, s59, 0x800000
    buffer_load_dwordx4 v[120:123], v4, s[28:31], s59 offen
    buffer_load_dwordx4 v[124:127], v4, s[28:31], s59 offen offset:1024
    s_waitcnt vmcnt(14)
    v_mfma_f32_32x32x16_bf16 v[192:207], v[24:27], v[16:19], 0
    s_add_u32 s55, s55, 1024
    s_cmp_eq_u32 s55, 8192
    s_cselect_b32 s55, 0, s55
    v_add_u32 v5, s55, v4
    buffer_load_dwordx4 v[72:75], v5, s[28:31], s52 offen
    buffer_load_dwordx4 v[64:67], v5, s[28:31], s50 offen
    v_mfma_f32_32x32x16_bf16 v[224:239], v[24:27], v[20:23], 0
    buffer_load_dwordx4 v[68:71], v5, s[28:31], s51 offen
    buffer_load_dwordx4 v[76:79], v5, s[28:31], s53 offen
    v_mfma_f32_32x32x16_bf16 v[208:223], v[28:31], v[16:19], 0
    s_add_u32 s55, s55, 1024
    s_cmp_eq_u32 s55, 8192
    s_cselect_b32 s55, 0, s55
    v_add_u32 v5, s55, v4
    buffer_load_dwordx4 v[88:91], v5, s[28:31], s52 offen
    buffer_load_dwordx4 v[80:83], v5, s[28:31], s50 offen
    v_mfma_f32_32x32x16_bf16 v[240:255], v[28:31], v[20:23], 0
    buffer_load_dwordx4 v[84:87], v5, s[28:31], s51 offen
    buffer_load_dwordx4 v[92:95], v5, s[28:31], s53 offen
    s_waitcnt vmcnt(18)
    v_mfma_f32_32x32x16_bf16 v[192:207], v[40:43], v[32:35], v[192:207]
    s_add_u32 s55, s55, 1024
    s_cmp_eq_u32 s55, 8192
    s_cselect_b32 s55, 0, s55
    v_add_u32 v5, s55, v4
    buffer_load_dwordx4 v[104:107], v5, s[28:31], s52 offen
    buffer_load_dwordx4 v[96:99], v5, s[28:31], s50 offen
    v_mfma_f32_32x32x16_bf16 v[224:239], v[40:43], v[36:39], v[224:239]
    buffer_load_dwordx4 v[100:103], v5, s[28:31], s51 offen
    buffer_load_dwordx4 v[108:111], v5, s[28:31], s53 offen
    v_mfma_f32_32x32x16_bf16 v[208:223], v[44:47], v[32:35], v[208:223]
    s_add_u32 s55, s55, 1024
    s_cmp_eq_u32 s55, 8192
    s_cselect_b32 s55, 0, s55
    v_add_u32 v5, s55, v4
    buffer_load_dwordx4 v[24:27], v5, s[28:31], s52 offen
    buffer_load_dwordx4 v[16:19], v5, s[28:31], s50 offen
    v_mfma_f32_32x32x16_bf16 v[240:255], v[44:47], v[36:39], v[240:255]
    buffer_load_dwordx4 v[20:23], v5, s[28:31], s51 offen
    buffer_load_dwordx4 v[28:31], v5, s[28:31], s53 offen
    s_waitcnt vmcnt(22)
    v_mfma_f32_32x32x16_bf16 v[192:207], v[56:59], v[48:51], v[192:207]
    s_add_u32 s55, s55, 1024
    s_cmp_eq_u32 s55, 8192
    s_cselect_b32 s55, 0, s55
    v_add_u32 v5, s55, v4
    buffer_load_dwordx4 v[40:43], v5, s[28:31], s52 offen
    v_mfma_f32_32x32x16_bf16 v[224:239], v[56:59], v[52:55], v[224:239]
    buffer_load_dwordx4 v[32:35], v5, s[28:31], s50 offen
    v_mfma_f32_32x32x16_bf16 v[208:223], v[60:63], v[48:51], v[208:223]
    buffer_load_dwordx4 v[36:39], v5, s[28:31], s51 offen
    v_mfma_f32_32x32x16_bf16 v[240:255], v[60:63], v[52:55], v[240:255]
    buffer_load_dwordx4 v[44:47], v5, s[28:31], s53 offen
    s_waitcnt vmcnt(16)
    v_mfma_f32_32x32x16_bf16 v[192:207], v[72:75], v[64:67], v[192:207]
    s_lshl_b32 s50, s26, 1
    s_mul_i32 s50, s50, 112
    s_add_u32 s50, s50, s35
    s_lshl_b32 s50, s50, 10
    s_add_u32 s50, s50, 0xc00000
    s_add_u32 s51, s50, 0x1c000
    s_lshl_b32 s52, s27, 1
    s_mul_i32 s52, s52, 112
    s_add_u32 s52, s52, s35
    s_lshl_b32 s52, s52, 10
    s_add_u32 s52, s52, 0x1800000
    s_add_u32 s53, s52, 0x1c000
    s_lshl_b32 s55, s39, 10
    v_add_u32 v5, s55, v4
    buffer_load_dwordx4 v[56:59], v5, s[28:31], s52 offen
    v_mfma_f32_32x32x16_bf16 v[224:239], v[72:75], v[68:71], v[224:239]
    buffer_load_dwordx4 v[48:51], v5, s[28:31], s50 offen
    v_mfma_f32_32x32x16_bf16 v[208:223], v[76:79], v[64:67], v[208:223]
    buffer_load_dwordx4 v[52:55], v5, s[28:31], s51 offen
    v_mfma_f32_32x32x16_bf16 v[240:255], v[76:79], v[68:71], v[240:255]
    buffer_load_dwordx4 v[60:63], v5, s[28:31], s53 offen
    s_waitcnt vmcnt(16)
    v_mfma_f32_32x32x16_bf16 v[192:207], v[88:91], v[80:83], v[192:207]
    s_add_u32 s55, s55, 1024
    s_cmp_eq_u32 s55, 28672
    s_cselect_b32 s55, 0, s55
    v_add_u32 v5, s55, v4
    buffer_load_dwordx4 v[72:75], v5, s[28:31], s52 offen
    v_mfma_f32_32x32x16_bf16 v[224:239], v[88:91], v[84:87], v[224:239]
    buffer_load_dwordx4 v[64:67], v5, s[28:31], s50 offen
    v_mfma_f32_32x32x16_bf16 v[208:223], v[92:95], v[80:83], v[208:223]
    buffer_load_dwordx4 v[68:71], v5, s[28:31], s51 offen
    v_mfma_f32_32x32x16_bf16 v[240:255], v[92:95], v[84:87], v[240:255]
    buffer_load_dwordx4 v[76:79], v5, s[28:31], s53 offen
    s_waitcnt vmcnt(16)
    v_mfma_f32_32x32x16_bf16 v[192:207], v[104:107], v[96:99], v[192:207]
    s_add_u32 s55, s55, 1024
    s_cmp_eq_u32 s55, 28672
    s_cselect_b32 s55, 0, s55
    v_add_u32 v5, s55, v4
    buffer_load_dwordx4 v[88:91], v5, s[28:31], s52 offen
    v_mfma_f32_32x32x16_bf16 v[224:239], v[104:107], v[100:103], v[224:239]
    buffer_load_dwordx4 v[80:83], v5, s[28:31], s50 offen
    v_mfma_f32_32x32x16_bf16 v[208:223], v[108:111], v[96:99], v[208:223]
    buffer_load_dwordx4 v[84:87], v5, s[28:31], s51 offen
    v_mfma_f32_32x32x16_bf16 v[240:255], v[108:111], v[100:103], v[240:255]
    buffer_load_dwordx4 v[92:95], v5, s[28:31], s53 offen
    s_waitcnt vmcnt(16)
    v_mfma_f32_32x32x16_bf16 v[192:207], v[24:27], v[16:19], v[192:207]
    s_add_u32 s55, s55, 1024
    s_cmp_eq_u32 s55, 28672
    s_cselect_b32 s55, 0, s55
    v_add_u32 v5, s55, v4
    buffer_load_dwordx4 v[104:107], v5, s[28:31], s52 offen
    v_mfma_f32_32x32x16_bf16 v[224:239], v[24:27], v[20:23], v[224:239]
    buffer_load_dwordx4 v[96:99], v5, s[28:31], s50 offen
    v_mfma_f32_32x32x16_bf16 v[208:223], v[28:31], v[16:19], v[208:223]
    buffer_load_dwordx4 v[100:103], v5, s[28:31], s51 offen
    v_mfma_f32_32x32x16_bf16 v[240:255], v[28:31], v[20:23], v[240:255]
    buffer_load_dwordx4 v[108:111], v5, s[28:31], s53 offen
    s_waitcnt vmcnt(16)
    v_mfma_f32_32x32x16_bf16 v[192:207], v[40:43], v[32:35], v[192:207]
    s_add_u32 s55, s55, 1024
    s_cmp_eq_u32 s55, 28672
    s_cselect_b32 s55, 0, s55
    v_add_u32 v5, s55, v4
    buffer_load_dwordx4 v[24:27], v5, s[28:31], s52 offen
    v_mfma_f32_32x32x16_bf16 v[224:239], v[40:43], v[36:39], v[224:239]
    buffer_load_dwordx4 v[16:19], v5, s[28:31], s50 offen
    v_mfma_f32_32x32x16_bf16 v[208:223], v[44:47], v[32:35], v[208:223]
    buffer_load_dwordx4 v[20:23], v5, s[28:31], s51 offen
    v_mfma_f32_32x32x16_bf16 v[240:255], v[44:47], v[36:39], v[240:255]
    buffer_load_dwordx4 v[28:31], v5, s[28:31], s53 offen
    s_waitcnt vmcnt(16)
    v_mfma_f32_32x32x16_bf16 v[128:143], v[56:59], v[48:51], 0
    s_add_u32 s55, s55, 1024
    s_cmp_eq_u32 s55, 28672
    s_cselect_b32 s55, 0, s55
    v_add_u32 v5, s55, v4
    buffer_load_dwordx4 v[40:43], v5, s[28:31], s52 offen
    v_mfma_f32_32x32x16_bf16 v[160:175], v[56:59], v[52:55], 0
    buffer_load_dwordx4 v[32:35], v5, s[28:31], s50 offen
    v_mfma_f32_32x32x16_bf16 v[144:159], v[60:63], v[48:51], 0
    buffer_load_dwordx4 v[36:39], v5, s[28:31], s51 offen
    v_mfma_f32_32x32x16_bf16 v[176:191], v[60:63], v[52:55], 0
    buffer_load_dwordx4 v[44:47], v5, s[28:31], s53 offen
    s_waitcnt vmcnt(16)
    v_mfma_f32_32x32x16_bf16 v[128:143], v[72:75], v[64:67], v[128:143]
    s_add_u32 s55, s55, 1024
    s_cmp_eq_u32 s55, 28672
    s_cselect_b32 s55, 0, s55
    v_add_u32 v5, s55, v4
    buffer_load_dwordx4 v[56:59], v5, s[28:31], s52 offen
    v_mfma_f32_32x32x16_bf16 v[160:175], v[72:75], v[68:71], v[160:175]
    buffer_load_dwordx4 v[48:51], v5, s[28:31], s50 offen
    v_mfma_f32_32x32x16_bf16 v[144:159], v[76:79], v[64:67], v[144:159]
    buffer_load_dwordx4 v[52:55], v5, s[28:31], s51 offen
    v_mfma_f32_32x32x16_bf16 v[176:191], v[76:79], v[68:71], v[176:191]
    buffer_load_dwordx4 v[60:63], v5, s[28:31], s53 offen
    s_waitcnt vmcnt(16)
    v_mfma_f32_32x32x16_bf16 v[128:143], v[88:91], v[80:83], v[128:143]
    s_add_u32 s55, s55, 1024
    s_cmp_eq_u32 s55, 28672
    s_cselect_b32 s55, 0, s55
    v_add_u32 v5, s55, v4
    buffer_load_dwordx4 v[72:75], v5, s[28:31], s52 offen
    v_mfma_f32_32x32x16_bf16 v[160:175], v[88:91], v[84:87], v[160:175]
    buffer_load_dwordx4 v[64:67], v5, s[28:31], s50 offen
    v_mfma_f32_32x32x16_bf16 v[144:159], v[92:95], v[80:83], v[144:159]
    buffer_load_dwordx4 v[68:71], v5, s[28:31], s51 offen
    v_mfma_f32_32x32x16_bf16 v[176:191], v[92:95], v[84:87], v[176:191]
    buffer_load_dwordx4 v[76:79], v5, s[28:31], s53 offen
    s_waitcnt vmcnt(16)
    v_mfma_f32_32x32x16_bf16 v[128:143], v[104:107], v[96:99], v[128:143]
    s_add_u32 s55, s55, 1024
    s_cmp_eq_u32 s55, 28672
    s_cselect_b32 s55, 0, s55
    v_add_u32 v5, s55, v4
    buffer_load_dwordx4 v[88:91], v5, s[28:31], s52 offen
    v_mfma_f32_32x32x16_bf16 v[160:175], v[104:107], v[100:103], v[160:175]
    buffer_load_dwordx4 v[80:83], v5, s[28:31], s50 offen
    v_mfma_f32_32x32x16_bf16 v[144:159], v[108:111], v[96:99], v[144:159]
    buffer_load_dwordx4 v[84:87], v5, s[28:31], s51 offen
    v_mfma_f32_32x32x16_bf16 v[176:191], v[108:111], v[100:103], v[176:191]
    buffer_load_dwordx4 v[92:95], v5, s[28:31], s53 offen
    s_waitcnt vmcnt(16)
    v_mfma_f32_32x32x16_bf16 v[128:143], v[24:27], v[16:19], v[128:143]
    s_add_u32 s55, s55, 1024
    s_cmp_eq_u32 s55, 28672
    s_cselect_b32 s55, 0, s55
    v_add_u32 v5, s55, v4
    buffer_load_dwordx4 v[104:107], v5, s[28:31], s52 offen
    v_mfma_f32_32x32x16_bf16 v[160:175], v[24:27], v[20:23], v[160:175]
    buffer_load_dwordx4 v[96:99], v5, s[28:31], s50 offen
    v_mfma_f32_32x32x16_bf16 v[144:159], v[28:31], v[16:19], v[144:159]
    buffer_load_dwordx4 v[100:103], v5, s[28:31], s51 offen
    v_mfma_f32_32x32x16_bf16 v[176:191], v[28:31], v[20:23], v[176:191]
    buffer_load_dwordx4 v[108:111], v5, s[28:31], s53 offen
    s_waitcnt vmcnt(16)
    v_mfma_f32_32x32x16_bf16 v[128:143], v[40:43], v[32:35], v[128:143]
    s_add_u32 s55, s55, 1024
    s_cmp_eq_u32 s55, 28672
    s_cselect_b32 s55, 0, s55
    v_add_u32 v5, s55, v4
    buffer_load_dwordx4 v[24:27], v5, s[28:31], s52 offen
    v_mfma_f32_32x32x16_bf16 v[160:175], v[40:43], v[36:39], v[160:175]
    buffer_load_dwordx4 v[16:19], v5, s[28:31], s50 offen
    v_mfma_f32_32x32x16_bf16 v[144:159], v[44:47], v[32:35], v[144:159]
    buffer_load_dwordx4 v[20:23], v5, s[28:31], s51 offen
    v_mfma_f32_32x32x16_bf16 v[176:191], v[44:47], v[36:39], v[176:191]
    buffer_load_dwordx4 v[28:31], v5, s[28:31], s53 offen
    s_waitcnt vmcnt(16)
    v_mfma_f32_32x32x16_bf16 v[128:143], v[56:59], v[48:51], v[128:143]
    s_add_u32 s55, s55, 1024
    s_cmp_eq_u32 s55, 28672
    s_cselect_b32 s55, 0, s55
    v_add_u32 v5, s55, v4
    buffer_load_dwordx4 v[40:43], v5, s[28:31], s52 offen
    v_mfma_f32_32x32x16_bf16 v[160:175], v[56:59], v[52:55], v[160:175]
    buffer_load_dwordx4 v[32:35], v5, s[28:31], s50 offen
    v_mfma_f32_32x32x16_bf16 v[144:159], v[60:63], v[48:51], v[144:159]
    buffer_load_dwordx4 v[36:39], v5, s[28:31], s51 offen
    v_mfma_f32_32x32x16_bf16 v[176:191], v[60:63], v[52:55], v[176:191]
    buffer_load_dwordx4 v[44:47], v5, s[28:31], s53 offen
    s_waitcnt vmcnt(16)
    v_mfma_f32_32x32x16_bf16 v[128:143], v[72:75], v[64:67], v[128:143]
    s_add_u32 s55, s55, 1024
    s_cmp_eq_u32 s55, 28672
    s_cselect_b32 s55, 0, s55
    v_add_u32 v5, s55, v4
    buffer_load_dwordx4 v[56:59], v5, s[28:31], s52 offen
    v_mfma_f32_32x32x16_bf16 v[160:175], v[72:75], v[68:71], v[160:175]
    buffer_load_dwordx4 v[48:51], v5, s[28:31], s50 offen
    v_mfma_f32_32x32x16_bf16 v[144:159], v[76:79], v[64:67], v[144:159]
    buffer_load_dwordx4 v[52:55], v5, s[28:31], s51 offen
    v_mfma_f32_32x32x16_bf16 v[176:191], v[76:79], v[68:71], v[176:191]
    buffer_load_dwordx4 v[60:63], v5, s[28:31], s53 offen
    s_waitcnt vmcnt(16)
    v_mfma_f32_32x32x16_bf16 v[128:143], v[88:91], v[80:83], v[128:143]
    s_add_u32 s55, s55, 1024
    s_cmp_eq_u32 s55, 28672
    s_cselect_b32 s55, 0, s55
    v_add_u32 v5, s55, v4
    buffer_load_dwordx4 v[72:75], v5, s[28:31], s52 offen
    v_mfma_f32_32x32x16_bf16 v[160:175], v[88:91], v[84:87], v[160:175]
    buffer_load_dwordx4 v[64:67], v5, s[28:31], s50 offen
    v_mfma_f32_32x32x16_bf16 v[144:159], v[92:95], v[80:83], v[144:159]
    buffer_load_dwordx4 v[68:71], v5, s[28:31], s51 offen
    v_mfma_f32_32x32x16_bf16 v[176:191], v[92:95], v[84:87], v[176:191]
    buffer_load_dwordx4 v[76:79], v5, s[28:31], s53 offen
    s_waitcnt vmcnt(16)
    v_mfma_f32_32x32x16_bf16 v[128:143], v[104:107], v[96:99], v[128:143]
    s_add_u32 s55, s55, 1024
    s_cmp_eq_u32 s55, 28672
    s_cselect_b32 s55, 0, s55
    v_add_u32 v5, s55, v4
    buffer_load_dwordx4 v[88:91], v5, s[28:31], s52 offen
    v_mfma_f32_32x32x16_bf16 v[160:175], v[104:107], v[100:103], v[160:175]
    buffer_load_dwordx4 v[80:83], v5, s[28:31], s50 offen
    v_mfma_f32_32x32x16_bf16 v[144:159], v[108:111], v[96:99], v[144:159]
    buffer_load_dwordx4 v[84:87], v5, s[28:31], s51 offen
    v_mfma_f32_32x32x16_bf16 v[176:191], v[108:111], v[100:103], v[176:191]
    buffer_load_dwordx4 v[92:95], v5, s[28:31], s53 offen
    s_waitcnt vmcnt(16)
    v_mfma_f32_32x32x16_bf16 v[128:143], v[24:27], v[16:19], v[128:143]
    s_add_u32 s55, s55, 1024
    s_cmp_eq_u32 s55, 28672
    s_cselect_b32 s55, 0, s55
    v_add_u32 v5, s55, v4
    buffer_load_dwordx4 v[104:107], v5, s[28:31], s52 offen
    v_mfma_f32_32x32x16_bf16 v[160:175], v[24:27], v[20:23], v[160:175]
    buffer_load_dwordx4 v[96:99], v5, s[28:31], s50 offen
    v_mfma_f32_32x32x16_bf16 v[144:159], v[28:31], v[16:19], v[144:159]
    buffer_load_dwordx4 v[100:103], v5, s[28:31], s51 offen
    v_mfma_f32_32x32x16_bf16 v[176:191], v[28:31], v[20:23], v[176:191]
    buffer_load_dwordx4 v[108:111], v5, s[28:31], s53 offen
    s_waitcnt vmcnt(16)
    v_mfma_f32_32x32x16_bf16 v[128:143], v[40:43], v[32:35], v[128:143]
    s_add_u32 s55, s55, 1024
    s_cmp_eq_u32 s55, 28672
    s_cselect_b32 s55, 0, s55
    v_add_u32 v5, s55, v4
    buffer_load_dwordx4 v[24:27], v5, s[28:31], s52 offen
    v_mfma_f32_32x32x16_bf16 v[160:175], v[40:43], v[36:39], v[160:175]
    buffer_load_dwordx4 v[16:19], v5, s[28:31], s50 offen
    v_mfma_f32_32x32x16_bf16 v[144:159], v[44:47], v[32:35], v[144:159]
    buffer_load_dwordx4 v[20:23], v5, s[28:31], s51 offen
    v_mfma_f32_32x32x16_bf16 v[176:191], v[44:47], v[36:39], v[176:191]
    buffer_load_dwordx4 v[28:31], v5, s[28:31], s53 offen
    s_waitcnt vmcnt(16)
    v_mfma_f32_32x32x16_bf16 v[128:143], v[56:59], v[48:51], v[128:143]
    s_add_u32 s55, s55, 1024
    s_cmp_eq_u32 s55, 28672
    s_cselect_b32 s55, 0, s55
    v_add_u32 v5, s55, v4
    buffer_load_dwordx4 v[40:43], v5, s[28:31], s52 offen
    v_mfma_f32_32x32x16_bf16 v[160:175], v[56:59], v[52:55], v[160:175]
    buffer_load_dwordx4 v[32:35], v5, s[28:31], s50 offen
    v_mfma_f32_32x32x16_bf16 v[144:159], v[60:63], v[48:51], v[144:159]
    buffer_load_dwordx4 v[36:39], v5, s[28:31], s51 offen
    v_mfma_f32_32x32x16_bf16 v[176:191], v[60:63], v[52:55], v[176:191]
    buffer_load_dwordx4 v[44:47], v5, s[28:31], s53 offen
    s_waitcnt vmcnt(16)
    v_mfma_f32_32x32x16_bf16 v[128:143], v[72:75], v[64:67], v[128:143]
    s_add_u32 s55, s55, 1024
    s_cmp_eq_u32 s55, 28672
    s_cselect_b32 s55, 0, s55
    v_add_u32 v5, s55, v4
    buffer_load_dwordx4 v[56:59], v5, s[28:31], s52 offen
    v_mfma_f32_32x32x16_bf16 v[160:175], v[72:75], v[68:71], v[160:175]
    buffer_load_dwordx4 v[48:51], v5, s[28:31], s50 offen
    v_mfma_f32_32x32x16_bf16 v[144:159], v[76:79], v[64:67], v[144:159]
    buffer_load_dwordx4 v[52:55], v5, s[28:31], s51 offen
    v_mfma_f32_32x32x16_bf16 v[176:191], v[76:79], v[68:71], v[176:191]
    buffer_load_dwordx4 v[60:63], v5, s[28:31], s53 offen
    s_waitcnt vmcnt(16)
    v_mfma_f32_32x32x16_bf16 v[128:143], v[88:91], v[80:83], v[128:143]
    s_add_u32 s55, s55, 1024
    s_cmp_eq_u32 s55, 28672
    s_cselect_b32 s55, 0, s55
    v_add_u32 v5, s55, v4
    buffer_load_dwordx4 v[72:75], v5, s[28:31], s52 offen
    v_mfma_f32_32x32x16_bf16 v[160:175], v[88:91], v[84:87], v[160:175]
    buffer_load_dwordx4 v[64:67], v5, s[28:31], s50 offen
    v_mfma_f32_32x32x16_bf16 v[144:159], v[92:95], v[80:83], v[144:159]
    buffer_load_dwordx4 v[68:71], v5, s[28:31], s51 offen
    v_mfma_f32_32x32x16_bf16 v[176:191], v[92:95], v[84:87], v[176:191]
    buffer_load_dwordx4 v[76:79], v5, s[28:31], s53 offen
    s_waitcnt vmcnt(16)
    v_mfma_f32_32x32x16_bf16 v[128:143], v[104:107], v[96:99], v[128:143]
    s_add_u32 s55, s55, 1024
    s_cmp_eq_u32 s55, 28672
    s_cselect_b32 s55, 0, s55
    v_add_u32 v5, s55, v4
    buffer_load_dwordx4 v[88:91], v5, s[28:31], s52 offen
    v_mfma_f32_32x32x16_bf16 v[160:175], v[104:107], v[100:103], v[160:175]
    buffer_load_dwordx4 v[80:83], v5, s[28:31], s50 offen
    v_mfma_f32_32x32x16_bf16 v[144:159], v[108:111], v[96:99], v[144:159]
    buffer_load_dwordx4 v[84:87], v5, s[28:31], s51 offen
    v_mfma_f32_32x32x16_bf16 v[176:191], v[108:111], v[100:103], v[176:191]
    buffer_load_dwordx4 v[92:95], v5, s[28:31], s53 offen
    s_waitcnt vmcnt(16)
    v_mfma_f32_32x32x16_bf16 v[128:143], v[24:27], v[16:19], v[128:143]
    s_add_u32 s55, s55, 1024
    s_cmp_eq_u32 s55, 28672
    s_cselect_b32 s55, 0, s55
    v_add_u32 v5, s55, v4
    buffer_load_dwordx4 v[104:107], v5, s[28:31], s52 offen
    v_mfma_f32_32x32x16_bf16 v[160:175], v[24:27], v[20:23], v[160:175]
    buffer_load_dwordx4 v[96:99], v5, s[28:31], s50 offen
    v_mfma_f32_32x32x16_bf16 v[144:159], v[28:31], v[16:19], v[144:159]
    buffer_load_dwordx4 v[100:103], v5, s[28:31], s51 offen
    v_mfma_f32_32x32x16_bf16 v[176:191], v[28:31], v[20:23], v[176:191]
    buffer_load_dwordx4 v[108:111], v5, s[28:31], s53 offen
    s_waitcnt vmcnt(16)
    v_mfma_f32_32x32x16_bf16 v[128:143], v[40:43], v[32:35], v[128:143]
    s_add_u32 s55, s55, 1024
    s_cmp_eq_u32 s55, 28672
    s_cselect_b32 s55, 0, s55
    v_add_u32 v5, s55, v4
    buffer_load_dwordx4 v[24:27], v5, s[28:31], s52 offen
    v_mfma_f32_32x32x16_bf16 v[160:175], v[40:43], v[36:39], v[160:175]
    buffer_load_dwordx4 v[16:19], v5, s[28:31], s50 offen
    v_mfma_f32_32x32x16_bf16 v[144:159], v[44:47], v[32:35], v[144:159]
    buffer_load_dwordx4 v[20:23], v5, s[28:31], s51 offen
    v_mfma_f32_32x32x16_bf16 v[176:191], v[44:47], v[36:39], v[176:191]
    buffer_load_dwordx4 v[28:31], v5, s[28:31], s53 offen
    s_waitcnt vmcnt(16)
    v_mfma_f32_32x32x16_bf16 v[128:143], v[56:59], v[48:51], v[128:143]
    s_add_u32 s55, s55, 1024
    s_cmp_eq_u32 s55, 28672
    s_cselect_b32 s55, 0, s55
    v_add_u32 v5, s55, v4
    buffer_load_dwordx4 v[40:43], v5, s[28:31], s52 offen
    v_mfma_f32_32x32x16_bf16 v[160:175], v[56:59], v[52:55], v[160:175]
    buffer_load_dwordx4 v[32:35], v5, s[28:31], s50 offen
    v_mfma_f32_32x32x16_bf16 v[144:159], v[60:63], v[48:51], v[144:159]
    buffer_load_dwordx4 v[36:39], v5, s[28:31], s51 offen
    v_mfma_f32_32x32x16_bf16 v[176:191], v[60:63], v[52:55], v[176:191]
    buffer_load_dwordx4 v[44:47], v5, s[28:31], s53 offen
    s_waitcnt vmcnt(16)
    v_mfma_f32_32x32x16_bf16 v[128:143], v[72:75], v[64:67], v[128:143]
    s_add_u32 s55, s55, 1024
    s_cmp_eq_u32 s55, 28672
    s_cselect_b32 s55, 0, s55
    v_add_u32 v5, s55, v4
    buffer_load_dwordx4 v[56:59], v5, s[28:31], s52 offen
    v_mfma_f32_32x32x16_bf16 v[160:175], v[72:75], v[68:71], v[160:175]
    buffer_load_dwordx4 v[48:51], v5, s[28:31], s50 offen
    v_mfma_f32_32x32x16_bf16 v[144:159], v[76:79], v[64:67], v[144:159]
    buffer_load_dwordx4 v[52:55], v5, s[28:31], s51 offen
    v_mfma_f32_32x32x16_bf16 v[176:191], v[76:79], v[68:71], v[176:191]
    buffer_load_dwordx4 v[60:63], v5, s[28:31], s53 offen
    s_waitcnt vmcnt(16)
    v_mfma_f32_32x32x16_bf16 v[128:143], v[88:91], v[80:83], v[128:143]
    s_add_u32 s55, s55, 1024
    s_cmp_eq_u32 s55, 28672
    s_cselect_b32 s55, 0, s55
    v_add_u32 v5, s55, v4
    buffer_load_dwordx4 v[72:75], v5, s[28:31], s52 offen
    v_mfma_f32_32x32x16_bf16 v[160:175], v[88:91], v[84:87], v[160:175]
    buffer_load_dwordx4 v[64:67], v5, s[28:31], s50 offen
    v_mfma_f32_32x32x16_bf16 v[144:159], v[92:95], v[80:83], v[144:159]
    buffer_load_dwordx4 v[68:71], v5, s[28:31], s51 offen
    v_mfma_f32_32x32x16_bf16 v[176:191], v[92:95], v[84:87], v[176:191]
    buffer_load_dwordx4 v[76:79], v5, s[28:31], s53 offen
    s_waitcnt vmcnt(16)
    v_mfma_f32_32x32x16_bf16 v[128:143], v[104:107], v[96:99], v[128:143]
    s_add_u32 s55, s55, 1024
    s_cmp_eq_u32 s55, 28672
    s_cselect_b32 s55, 0, s55
    v_add_u32 v5, s55, v4
    buffer_load_dwordx4 v[88:91], v5, s[28:31], s52 offen
    v_mfma_f32_32x32x16_bf16 v[160:175], v[104:107], v[100:103], v[160:175]
    buffer_load_dwordx4 v[80:83], v5, s[28:31], s50 offen
    v_mfma_f32_32x32x16_bf16 v[144:159], v[108:111], v[96:99], v[144:159]
    buffer_load_dwordx4 v[84:87], v5, s[28:31], s51 offen
    v_mfma_f32_32x32x16_bf16 v[176:191], v[108:111], v[100:103], v[176:191]
    buffer_load_dwordx4 v[92:95], v5, s[28:31], s53 offen
    s_waitcnt vmcnt(16)
    v_mfma_f32_32x32x16_bf16 v[128:143], v[24:27], v[16:19], v[128:143]
    s_add_u32 s55, s55, 1024
    s_cmp_eq_u32 s55, 28672
    s_cselect_b32 s55, 0, s55
    v_add_u32 v5, s55, v4
    buffer_load_dwordx4 v[104:107], v5, s[28:31], s52 offen
    v_mfma_f32_32x32x16_bf16 v[160:175], v[24:27], v[20:23], v[160:175]
    buffer_load_dwordx4 v[96:99], v5, s[28:31], s50 offen
    v_mfma_f32_32x32x16_bf16 v[144:159], v[28:31], v[16:19], v[144:159]
    buffer_load_dwordx4 v[100:103], v5, s[28:31], s51 offen
    v_mfma_f32_32x32x16_bf16 v[176:191], v[28:31], v[20:23], v[176:191]
    buffer_load_dwordx4 v[108:111], v5, s[28:31], s53 offen
    s_waitcnt vmcnt(16)
    v_mfma_f32_32x32x16_bf16 v[128:143], v[40:43], v[32:35], v[128:143]
    v_mfma_f32_32x32x16_bf16 v[160:175], v[40:43], v[36:39], v[160:175]
    v_mfma_f32_32x32x16_bf16 v[144:159], v[44:47], v[32:35], v[144:159]
    v_mfma_f32_32x32x16_bf16 v[176:191], v[44:47], v[36:39], v[176:191]
    s_waitcnt vmcnt(12)
    v_mfma_f32_32x32x16_bf16 v[128:143], v[56:59], v[48:51], v[128:143]
    v_mfma_f32_32x32x16_bf16 v[160:175], v[56:59], v[52:55], v[160:175]
    v_mfma_f32_32x32x16_bf16 v[144:159], v[60:63], v[48:51], v[144:159]
    v_mfma_f32_32x32x16_bf16 v[176:191], v[60:63], v[52:55], v[176:191]
    s_waitcnt vmcnt(8)
    v_mfma_f32_32x32x16_bf16 v[128:143], v[72:75], v[64:67], v[128:143]
    v_mfma_f32_32x32x16_bf16 v[160:175], v[72:75], v[68:71], v[160:175]
    v_mfma_f32_32x32x16_bf16 v[144:159], v[76:79], v[64:67], v[144:159]
    v_mfma_f32_32x32x16_bf16 v[176:191], v[76:79], v[68:71], v[176:191]
    s_waitcnt vmcnt(4)
    v_mfma_f32_32x32x16_bf16 v[128:143], v[88:91], v[80:83], v[128:143]
    v_mfma_f32_32x32x16_bf16 v[160:175], v[88:91], v[84:87], v[160:175]
    v_mfma_f32_32x32x16_bf16 v[144:159], v[92:95], v[80:83], v[144:159]
    v_mfma_f32_32x32x16_bf16 v[176:191], v[92:95], v[84:87], v[176:191]
    s_waitcnt vmcnt(0)
    v_mfma_f32_32x32x16_bf16 v[128:143], v[104:107], v[96:99], v[128:143]
    v_mfma_f32_32x32x16_bf16 v[160:175], v[104:107], v[100:103], v[160:175]
    v_mfma_f32_32x32x16_bf16 v[144:159], v[108:111], v[96:99], v[144:159]
    v_mfma_f32_32x32x16_bf16 v[176:191], v[108:111], v[100:103], v[176:191]
    s_nop 15
    s_mul_i32 s58, s33, 24576
    s_add_u32 s58, s58, 0
    v_lshlrev_b32 v4, 4, v2
    v_add_u32 v5, s58, v4
    s_cmp_eq_u32 s33, 1
    s_cbranch_scc1 rs_w_47
    s_cmp_eq_u32 s33, 2
    s_cbranch_scc1 rs_w_48
    s_cmp_eq_u32 s33, 3
    s_cbranch_scc1 rs_w_49
    ds_write_b128 v5, v[144:147] offset:0
    ds_write_b128 v5, v[148:151] offset:1024
    ds_write_b128 v5, v[152:155] offset:2048
    ds_write_b128 v5, v[156:159] offset:3072
    ds_write_b128 v5, v[160:163] offset:4096
    ds_write_b128 v5, v[164:167] offset:5120
    ds_write_b128 v5, v[168:171] offset:6144
    ds_write_b128 v5, v[172:175] offset:7168
    ds_write_b128 v5, v[176:179] offset:8192
    ds_write_b128 v5, v[180:183] offset:9216
    ds_write_b128 v5, v[184:187] offset:10240
    ds_write_b128 v5, v[188:191] offset:11264
    ds_write_b128 v5, v[208:211] offset:12288
    ds_write_b128 v5, v[212:215] offset:13312
    ds_write_b128 v5, v[216:219] offset:14336
    ds_write_b128 v5, v[220:223] offset:15360
    ds_write_b128 v5, v[224:227] offset:16384
    ds_write_b128 v5, v[228:231] offset:17408
    ds_write_b128 v5, v[232:235] offset:18432
    ds_write_b128 v5, v[236:239] offset:19456
    ds_write_b128 v5, v[240:243] offset:20480
    ds_write_b128 v5, v[244:247] offset:21504
    ds_write_b128 v5, v[248:251] offset:22528
    ds_write_b128 v5, v[252:255] offset:23552
    s_waitcnt lgkmcnt(0)
    s_barrier
    v_add_u32 v6, 0x6000, v5
    ds_read_b128 v[144:147], v6 offset:0
    ds_read_b128 v[148:151], v6 offset:1024
    ds_read_b128 v[152:155], v6 offset:2048
    ds_read_b128 v[156:159], v6 offset:3072
    v_add_u32 v7, 0xc000, v5
    ds_read_b128 v[160:163], v7 offset:0
    ds_read_b128 v[164:167], v7 offset:1024
    ds_read_b128 v[168:171], v7 offset:2048
    ds_read_b128 v[172:175], v7 offset:3072
    v_add_u32 v8, 0x12000, v5
    ds_read_b128 v[176:179], v8 offset:0
    ds_read_b128 v[180:183], v8 offset:1024
    ds_read_b128 v[184:187], v8 offset:2048
    ds_read_b128 v[188:191], v8 offset:3072
    v_add_u32 v6, 0x6000, v5
    ds_read_b128 v[208:211], v6 offset:12288
    ds_read_b128 v[212:215], v6 offset:13312
    ds_read_b128 v[216:219], v6 offset:14336
    ds_read_b128 v[220:223], v6 offset:15360
    v_add_u32 v7, 0xc000, v5
    ds_read_b128 v[224:227], v7 offset:12288
    ds_read_b128 v[228:231], v7 offset:13312
    ds_read_b128 v[232:235], v7 offset:14336
    ds_read_b128 v[236:239], v7 offset:15360
    v_add_u32 v8, 0x12000, v5
    ds_read_b128 v[240:243], v8 offset:12288
    ds_read_b128 v[244:247], v8 offset:13312
    ds_read_b128 v[248:251], v8 offset:14336
    ds_read_b128 v[252:255], v8 offset:15360
    s_waitcnt lgkmcnt(15)
    v_pk_add_f32 v[144:145], v[144:145], v[160:161]
    v_pk_add_f32 v[146:147], v[146:147], v[162:163]
    v_pk_add_f32 v[148:149], v[148:149], v[164:165]
    v_pk_add_f32 v[150:151], v[150:151], v[166:167]
    v_pk_add_f32 v[152:153], v[152:153], v[168:169]
    v_pk_add_f32 v[154:155], v[154:155], v[170:171]
    v_pk_add_f32 v[156:157], v[156:157], v[172:173]
    v_pk_add_f32 v[158:159], v[158:159], v[174:175]
    s_waitcnt lgkmcnt(12)
    v_pk_add_f32 v[176:177], v[176:177], v[128:129]
    v_pk_add_f32 v[178:179], v[178:179], v[130:131]
    v_pk_add_f32 v[180:181], v[180:181], v[132:133]
    v_pk_add_f32 v[182:183], v[182:183], v[134:135]
    v_pk_add_f32 v[184:185], v[184:185], v[136:137]
    v_pk_add_f32 v[186:187], v[186:187], v[138:139]
    v_pk_add_f32 v[188:189], v[188:189], v[140:141]
    v_pk_add_f32 v[190:191], v[190:191], v[142:143]
    v_pk_add_f32 v[128:129], v[144:145], v[176:177]
    v_pk_add_f32 v[130:131], v[146:147], v[178:179]
    v_pk_add_f32 v[132:133], v[148:149], v[180:181]
    v_pk_add_f32 v[134:135], v[150:151], v[182:183]
    v_pk_add_f32 v[136:137], v[152:153], v[184:185]
    v_pk_add_f32 v[138:139], v[154:155], v[186:187]
    v_pk_add_f32 v[140:141], v[156:157], v[188:189]
    v_pk_add_f32 v[142:143], v[158:159], v[190:191]
    s_waitcnt lgkmcnt(4)
    v_pk_add_f32 v[208:209], v[208:209], v[224:225]
    v_pk_add_f32 v[210:211], v[210:211], v[226:227]
    v_pk_add_f32 v[212:213], v[212:213], v[228:229]
    v_pk_add_f32 v[214:215], v[214:215], v[230:231]
    v_pk_add_f32 v[216:217], v[216:217], v[232:233]
    v_pk_add_f32 v[218:219], v[218:219], v[234:235]
    v_pk_add_f32 v[220:221], v[220:221], v[236:237]
    v_pk_add_f32 v[222:223], v[222:223], v[238:239]
    s_waitcnt lgkmcnt(0)
    v_pk_add_f32 v[240:241], v[240:241], v[192:193]
    v_pk_add_f32 v[242:243], v[242:243], v[194:195]
    v_pk_add_f32 v[244:245], v[244:245], v[196:197]
    v_pk_add_f32 v[246:247], v[246:247], v[198:199]
    v_pk_add_f32 v[248:249], v[248:249], v[200:201]
    v_pk_add_f32 v[250:251], v[250:251], v[202:203]
    v_pk_add_f32 v[252:253], v[252:253], v[204:205]
    v_pk_add_f32 v[254:255], v[254:255], v[206:207]
    v_pk_add_f32 v[192:193], v[208:209], v[240:241]
    v_pk_add_f32 v[194:195], v[210:211], v[242:243]
    v_pk_add_f32 v[196:197], v[212:213], v[244:245]
    v_pk_add_f32 v[198:199], v[214:215], v[246:247]
    v_pk_add_f32 v[200:201], v[216:217], v[248:249]
    v_pk_add_f32 v[202:203], v[218:219], v[250:251]
    v_pk_add_f32 v[204:205], v[220:221], v[252:253]
    v_pk_add_f32 v[206:207], v[222:223], v[254:255]
    s_branch rs_end_45
rs_w_47:
    ds_write_b128 v5, v[128:131] offset:0
    ds_write_b128 v5, v[132:135] offset:1024
    ds_write_b128 v5, v[136:139] offset:2048
    ds_write_b128 v5, v[140:143] offset:3072
    ds_write_b128 v5, v[160:163] offset:4096
    ds_write_b128 v5, v[164:167] offset:5120
    ds_write_b128 v5, v[168:171] offset:6144
    ds_write_b128 v5, v[172:175] offset:7168
    ds_write_b128 v5, v[176:179] offset:8192
    ds_write_b128 v5, v[180:183] offset:9216
    ds_write_b128 v5, v[184:187] offset:10240
    ds_write_b128 v5, v[188:191] offset:11264
    ds_write_b128 v5, v[192:195] offset:12288
    ds_write_b128 v5, v[196:199] offset:13312
    ds_write_b128 v5, v[200:203] offset:14336
    ds_write_b128 v5, v[204:207] offset:15360
    ds_write_b128 v5, v[224:227] offset:16384
    ds_write_b128 v5, v[228:231] offset:17408
    ds_write_b128 v5, v[232:235] offset:18432
    ds_write_b128 v5, v[236:239] offset:19456
    ds_write_b128 v5, v[240:243] offset:20480
    ds_write_b128 v5, v[244:247] offset:21504
    ds_write_b128 v5, v[248:251] offset:22528
    ds_write_b128 v5, v[252:255] offset:23552
    s_waitcnt lgkmcnt(0)
    s_barrier
    v_add_u32 v6, 0xffffa000, v5
    ds_read_b128 v[128:131], v6 offset:0
    ds_read_b128 v[132:135], v6 offset:1024
    ds_read_b128 v[136:139], v6 offset:2048
    ds_read_b128 v[140:143], v6 offset:3072
    v_add_u32 v7, 0x6000, v5
    ds_read_b128 v[160:163], v7 offset:4096
    ds_read_b128 v[164:167], v7 offset:5120
    ds_read_b128 v[168:171], v7 offset:6144
    ds_read_b128 v[172:175], v7 offset:7168
    v_add_u32 v8, 0xc000, v5
    ds_read_b128 v[176:179], v8 offset:4096
    ds_read_b128 v[180:183], v8 offset:5120
    ds_read_b128 v[184:187], v8 offset:6144
    ds_read_b128 v[188:191], v8 offset:7168
    v_add_u32 v6, 0xffffa000, v5
    ds_read_b128 v[192:195], v6 offset:12288
    ds_read_b128 v[196:199], v6 offset:13312
    ds_read_b128 v[200:203], v6 offset:14336
    ds_read_b128 v[204:207], v6 offset:15360
    v_add_u32 v7, 0x6000, v5
    ds_read_b128 v[224:227], v7 offset:16384
    ds_read_b128 v[228:231], v7 offset:17408
    ds_read_b128 v[232:235], v7 offset:18432
    ds_read_b128 v[236:239], v7 offset:19456
    v_add_u32 v8, 0xc000, v5
    ds_read_b128 v[240:243], v8 offset:16384
    ds_read_b128 v[244:247], v8 offset:17408
    ds_read_b128 v[248:251], v8 offset:18432
    ds_read_b128 v[252:255], v8 offset:19456
    s_waitcnt lgkmcnt(15)
    v_pk_add_f32 v[128:129], v[128:129], v[160:161]
    v_pk_add_f32 v[130:131], v[130:131], v[162:163]
    v_pk_add_f32 v[132:133], v[132:133], v[164:165]
    v_pk_add_f32 v[134:135], v[134:135], v[166:167]
    v_pk_add_f32 v[136:137], v[136:137], v[168:169]
    v_pk_add_f32 v[138:139], v[138:139], v[170:171]
    v_pk_add_f32 v[140:141], v[140:141], v[172:173]
    v_pk_add_f32 v[142:143], v[142:143], v[174:175]
    s_waitcnt lgkmcnt(12)
    v_pk_add_f32 v[176:177], v[176:177], v[144:145]
    v_pk_add_f32 v[178:179], v[178:179], v[146:147]
    v_pk_add_f32 v[180:181], v[180:181], v[148:149]
    v_pk_add_f32 v[182:183], v[182:183], v[150:151]
    v_pk_add_f32 v[184:185], v[184:185], v[152:153]
    v_pk_add_f32 v[186:187], v[186:187], v[154:155]
    v_pk_add_f32 v[188:189], v[188:189], v[156:157]
    v_pk_add_f32 v[190:191], v[190:191], v[158:159]
    v_pk_add_f32 v[128:129], v[128:129], v[176:177]
    v_pk_add_f32 v[130:131], v[130:131], v[178:179]
    v_pk_add_f32 v[132:133], v[132:133], v[180:181]
    v_pk_add_f32 v[134:135], v[134:135], v[182:183]
    v_pk_add_f32 v[136:137], v[136:137], v[184:185]
    v_pk_add_f32 v[138:139], v[138:139], v[186:187]
    v_pk_add_f32 v[140:141], v[140:141], v[188:189]
    v_pk_add_f32 v[142:143], v[142:143], v[190:191]
    s_waitcnt lgkmcnt(4)
    v_pk_add_f32 v[192:193], v[192:193], v[224:225]
    v_pk_add_f32 v[194:195], v[194:195], v[226:227]
    v_pk_add_f32 v[196:197], v[196:197], v[228:229]
    v_pk_add_f32 v[198:199], v[198:199], v[230:231]
    v_pk_add_f32 v[200:201], v[200:201], v[232:233]
    v_pk_add_f32 v[202:203], v[202:203], v[234:235]
    v_pk_add_f32 v[204:205], v[204:205], v[236:237]
    v_pk_add_f32 v[206:207], v[206:207], v[238:239]
    s_waitcnt lgkmcnt(0)
    v_pk_add_f32 v[240:241], v[240:241], v[208:209]
    v_pk_add_f32 v[242:243], v[242:243], v[210:211]
    v_pk_add_f32 v[244:245], v[244:245], v[212:213]
    v_pk_add_f32 v[246:247], v[246:247], v[214:215]
    v_pk_add_f32 v[248:249], v[248:249], v[216:217]
    v_pk_add_f32 v[250:251], v[250:251], v[218:219]
    v_pk_add_f32 v[252:253], v[252:253], v[220:221]
    v_pk_add_f32 v[254:255], v[254:255], v[222:223]
    v_pk_add_f32 v[192:193], v[192:193], v[240:241]
    v_pk_add_f32 v[194:195], v[194:195], v[242:243]
    v_pk_add_f32 v[196:197], v[196:197], v[244:245]
    v_pk_add_f32 v[198:199], v[198:199], v[246:247]
    v_pk_add_f32 v[200:201], v[200:201], v[248:249]
    v_pk_add_f32 v[202:203], v[202:203], v[250:251]
    v_pk_add_f32 v[204:205], v[204:205], v[252:253]
    v_pk_add_f32 v[206:207], v[206:207], v[254:255]
    s_branch rs_end_45
rs_w_48:
    ds_write_b128 v5, v[128:131] offset:0
    ds_write_b128 v5, v[132:135] offset:1024
    ds_write_b128 v5, v[136:139] offset:2048
    ds_write_b128 v5, v[140:143] offset:3072
    ds_write_b128 v5, v[144:147] offset:4096
    ds_write_b128 v5, v[148:151] offset:5120
    ds_write_b128 v5, v[152:155] offset:6144
    ds_write_b128 v5, v[156:159] offset:7168
    ds_write_b128 v5, v[176:179] offset:8192
    ds_write_b128 v5, v[180:183] offset:9216
    ds_write_b128 v5, v[184:187] offset:10240
    ds_write_b128 v5, v[188:191] offset:11264
    ds_write_b128 v5, v[192:195] offset:12288
    ds_write_b128 v5, v[196:199] offset:13312
    ds_write_b128 v5, v[200:203] offset:14336
    ds_write_b128 v5, v[204:207] offset:15360
    ds_write_b128 v5, v[208:211] offset:16384
    ds_write_b128 v5, v[212:215] offset:17408
    ds_write_b128 v5, v[216:219] offset:18432
    ds_write_b128 v5, v[220:223] offset:19456
    ds_write_b128 v5, v[240:243] offset:20480
    ds_write_b128 v5, v[244:247] offset:21504
    ds_write_b128 v5, v[248:251] offset:22528
    ds_write_b128 v5, v[252:255] offset:23552
    s_waitcnt lgkmcnt(0)
    s_barrier
    v_add_u32 v6, 0xffff4000, v5
    ds_read_b128 v[128:131], v6 offset:4096
    ds_read_b128 v[132:135], v6 offset:5120
    ds_read_b128 v[136:139], v6 offset:6144
    ds_read_b128 v[140:143], v6 offset:7168
    v_add_u32 v7, 0xffffa000, v5
    ds_read_b128 v[144:147], v7 offset:4096
    ds_read_b128 v[148:151], v7 offset:5120
    ds_read_b128 v[152:155], v7 offset:6144
    ds_read_b128 v[156:159], v7 offset:7168
    v_add_u32 v8, 0x6000, v5
    ds_read_b128 v[176:179], v8 offset:8192
    ds_read_b128 v[180:183], v8 offset:9216
    ds_read_b128 v[184:187], v8 offset:10240
    ds_read_b128 v[188:191], v8 offset:11264
    v_add_u32 v6, 0xffff4000, v5
    ds_read_b128 v[192:195], v6 offset:16384
    ds_read_b128 v[196:199], v6 offset:17408
    ds_read_b128 v[200:203], v6 offset:18432
    ds_read_b128 v[204:207], v6 offset:19456
    v_add_u32 v7, 0xffffa000, v5
    ds_read_b128 v[208:211], v7 offset:16384
    ds_read_b128 v[212:215], v7 offset:17408
    ds_read_b128 v[216:219], v7 offset:18432
    ds_read_b128 v[220:223], v7 offset:19456
    v_add_u32 v8, 0x6000, v5
    ds_read_b128 v[240:243], v8 offset:20480
    ds_read_b128 v[244:247], v8 offset:21504
    ds_read_b128 v[248:251], v8 offset:22528
    ds_read_b128 v[252:255], v8 offset:23552
    s_waitcnt lgkmcnt(15)
    v_pk_add_f32 v[128:129], v[128:129], v[144:145]
    v_pk_add_f32 v[130:131], v[130:131], v[146:147]
    v_pk_add_f32 v[132:133], v[132:133], v[148:149]
    v_pk_add_f32 v[134:135], v[134:135], v[150:151]
    v_pk_add_f32 v[136:137], v[136:137], v[152:153]
    v_pk_add_f32 v[138:139], v[138:139], v[154:155]
    v_pk_add_f32 v[140:141], v[140:141], v[156:157]
    v_pk_add_f32 v[142:143], v[142:143], v[158:159]
    s_waitcnt lgkmcnt(12)
    v_pk_add_f32 v[176:177], v[176:177], v[160:161]
    v_pk_add_f32 v[178:179], v[178:179], v[162:163]
    v_pk_add_f32 v[180:181], v[180:181], v[164:165]
    v_pk_add_f32 v[182:183], v[182:183], v[166:167]
    v_pk_add_f32 v[184:185], v[184:185], v[168:169]
    v_pk_add_f32 v[186:187], v[186:187], v[170:171]
    v_pk_add_f32 v[188:189], v[188:189], v[172:173]
    v_pk_add_f32 v[190:191], v[190:191], v[174:175]
    v_pk_add_f32 v[128:129], v[128:129], v[176:177]
    v_pk_add_f32 v[130:131], v[130:131], v[178:179]
    v_pk_add_f32 v[132:133], v[132:133], v[180:181]
    v_pk_add_f32 v[134:135], v[134:135], v[182:183]
    v_pk_add_f32 v[136:137], v[136:137], v[184:185]
    v_pk_add_f32 v[138:139], v[138:139], v[186:187]
    v_pk_add_f32 v[140:141], v[140:141], v[188:189]
    v_pk_add_f32 v[142:143], v[142:143], v[190:191]
    s_waitcnt lgkmcnt(4)
    v_pk_add_f32 v[192:193], v[192:193], v[208:209]
    v_pk_add_f32 v[194:195], v[194:195], v[210:211]
    v_pk_add_f32 v[196:197], v[196:197], v[212:213]
    v_pk_add_f32 v[198:199], v[198:199], v[214:215]
    v_pk_add_f32 v[200:201], v[200:201], v[216:217]
    v_pk_add_f32 v[202:203], v[202:203], v[218:219]
    v_pk_add_f32 v[204:205], v[204:205], v[220:221]
    v_pk_add_f32 v[206:207], v[206:207], v[222:223]
    s_waitcnt lgkmcnt(0)
    v_pk_add_f32 v[240:241], v[240:241], v[224:225]
    v_pk_add_f32 v[242:243], v[242:243], v[226:227]
    v_pk_add_f32 v[244:245], v[244:245], v[228:229]
    v_pk_add_f32 v[246:247], v[246:247], v[230:231]
    v_pk_add_f32 v[248:249], v[248:249], v[232:233]
    v_pk_add_f32 v[250:251], v[250:251], v[234:235]
    v_pk_add_f32 v[252:253], v[252:253], v[236:237]
    v_pk_add_f32 v[254:255], v[254:255], v[238:239]
    v_pk_add_f32 v[192:193], v[192:193], v[240:241]
    v_pk_add_f32 v[194:195], v[194:195], v[242:243]
    v_pk_add_f32 v[196:197], v[196:197], v[244:245]
    v_pk_add_f32 v[198:199], v[198:199], v[246:247]
    v_pk_add_f32 v[200:201], v[200:201], v[248:249]
    v_pk_add_f32 v[202:203], v[202:203], v[250:251]
    v_pk_add_f32 v[204:205], v[204:205], v[252:253]
    v_pk_add_f32 v[206:207], v[206:207], v[254:255]
    s_branch rs_end_45
rs_w_49:
    ds_write_b128 v5, v[128:131] offset:0
    ds_write_b128 v5, v[132:135] offset:1024
    ds_write_b128 v5, v[136:139] offset:2048
    ds_write_b128 v5, v[140:143] offset:3072
    ds_write_b128 v5, v[144:147] offset:4096
    ds_write_b128 v5, v[148:151] offset:5120
    ds_write_b128 v5, v[152:155] offset:6144
    ds_write_b128 v5, v[156:159] offset:7168
    ds_write_b128 v5, v[160:163] offset:8192
    ds_write_b128 v5, v[164:167] offset:9216
    ds_write_b128 v5, v[168:171] offset:10240
    ds_write_b128 v5, v[172:175] offset:11264
    ds_write_b128 v5, v[192:195] offset:12288
    ds_write_b128 v5, v[196:199] offset:13312
    ds_write_b128 v5, v[200:203] offset:14336
    ds_write_b128 v5, v[204:207] offset:15360
    ds_write_b128 v5, v[208:211] offset:16384
    ds_write_b128 v5, v[212:215] offset:17408
    ds_write_b128 v5, v[216:219] offset:18432
    ds_write_b128 v5, v[220:223] offset:19456
    ds_write_b128 v5, v[224:227] offset:20480
    ds_write_b128 v5, v[228:231] offset:21504
    ds_write_b128 v5, v[232:235] offset:22528
    ds_write_b128 v5, v[236:239] offset:23552
    s_waitcnt lgkmcnt(0)
    s_barrier
    v_add_u32 v6, 0xfffee000, v5
    ds_read_b128 v[128:131], v6 offset:8192
    ds_read_b128 v[132:135], v6 offset:9216
    ds_read_b128 v[136:139], v6 offset:10240
    ds_read_b128 v[140:143], v6 offset:11264
    v_add_u32 v7, 0xffff4000, v5
    ds_read_b128 v[144:147], v7 offset:8192
    ds_read_b128 v[148:151], v7 offset:9216
    ds_read_b128 v[152:155], v7 offset:10240
    ds_read_b128 v[156:159], v7 offset:11264
    v_add_u32 v8, 0xffffa000, v5
    ds_read_b128 v[160:163], v8 offset:8192
    ds_read_b128 v[164:167], v8 offset:9216
    ds_read_b128 v[168:171], v8 offset:10240
    ds_read_b128 v[172:175], v8 offset:11264
    v_add_u32 v6, 0xfffee000, v5
    ds_read_b128 v[192:195], v6 offset:20480
    ds_read_b128 v[196:199], v6 offset:21504
    ds_read_b128 v[200:203], v6 offset:22528
    ds_read_b128 v[204:207], v6 offset:23552
    v_add_u32 v7, 0xffff4000, v5
    ds_read_b128 v[208:211], v7 offset:20480
    ds_read_b128 v[212:215], v7 offset:21504
    ds_read_b128 v[216:219], v7 offset:22528
    ds_read_b128 v[220:223], v7 offset:23552
    v_add_u32 v8, 0xffffa000, v5
    ds_read_b128 v[224:227], v8 offset:20480
    ds_read_b128 v[228:231], v8 offset:21504
    ds_read_b128 v[232:235], v8 offset:22528
    ds_read_b128 v[236:239], v8 offset:23552
    s_waitcnt lgkmcnt(15)
    v_pk_add_f32 v[128:129], v[128:129], v[144:145]
    v_pk_add_f32 v[130:131], v[130:131], v[146:147]
    v_pk_add_f32 v[132:133], v[132:133], v[148:149]
    v_pk_add_f32 v[134:135], v[134:135], v[150:151]
    v_pk_add_f32 v[136:137], v[136:137], v[152:153]
    v_pk_add_f32 v[138:139], v[138:139], v[154:155]
    v_pk_add_f32 v[140:141], v[140:141], v[156:157]
    v_pk_add_f32 v[142:143], v[142:143], v[158:159]
    s_waitcnt lgkmcnt(12)
    v_pk_add_f32 v[160:161], v[160:161], v[176:177]
    v_pk_add_f32 v[162:163], v[162:163], v[178:179]
    v_pk_add_f32 v[164:165], v[164:165], v[180:181]
    v_pk_add_f32 v[166:167], v[166:167], v[182:183]
    v_pk_add_f32 v[168:169], v[168:169], v[184:185]
    v_pk_add_f32 v[170:171], v[170:171], v[186:187]
    v_pk_add_f32 v[172:173], v[172:173], v[188:189]
    v_pk_add_f32 v[174:175], v[174:175], v[190:191]
    v_pk_add_f32 v[128:129], v[128:129], v[160:161]
    v_pk_add_f32 v[130:131], v[130:131], v[162:163]
    v_pk_add_f32 v[132:133], v[132:133], v[164:165]
    v_pk_add_f32 v[134:135], v[134:135], v[166:167]
    v_pk_add_f32 v[136:137], v[136:137], v[168:169]
    v_pk_add_f32 v[138:139], v[138:139], v[170:171]
    v_pk_add_f32 v[140:141], v[140:141], v[172:173]
    v_pk_add_f32 v[142:143], v[142:143], v[174:175]
    s_waitcnt lgkmcnt(4)
    v_pk_add_f32 v[192:193], v[192:193], v[208:209]
    v_pk_add_f32 v[194:195], v[194:195], v[210:211]
    v_pk_add_f32 v[196:197], v[196:197], v[212:213]
    v_pk_add_f32 v[198:199], v[198:199], v[214:215]
    v_pk_add_f32 v[200:201], v[200:201], v[216:217]
    v_pk_add_f32 v[202:203], v[202:203], v[218:219]
    v_pk_add_f32 v[204:205], v[204:205], v[220:221]
    v_pk_add_f32 v[206:207], v[206:207], v[222:223]
    s_waitcnt lgkmcnt(0)
    v_pk_add_f32 v[224:225], v[224:225], v[240:241]
    v_pk_add_f32 v[226:227], v[226:227], v[242:243]
    v_pk_add_f32 v[228:229], v[228:229], v[244:245]
    v_pk_add_f32 v[230:231], v[230:231], v[246:247]
    v_pk_add_f32 v[232:233], v[232:233], v[248:249]
    v_pk_add_f32 v[234:235], v[234:235], v[250:251]
    v_pk_add_f32 v[236:237], v[236:237], v[252:253]
    v_pk_add_f32 v[238:239], v[238:239], v[254:255]
    v_pk_add_f32 v[192:193], v[192:193], v[224:225]
    v_pk_add_f32 v[194:195], v[194:195], v[226:227]
    v_pk_add_f32 v[196:197], v[196:197], v[228:229]
    v_pk_add_f32 v[198:199], v[198:199], v[230:231]
    v_pk_add_f32 v[200:201], v[200:201], v[232:233]
    v_pk_add_f32 v[202:203], v[202:203], v[234:235]
    v_pk_add_f32 v[204:205], v[204:205], v[236:237]
    v_pk_add_f32 v[206:207], v[206:207], v[238:239]
rs_end_45:
    s_waitcnt vmcnt(0)
    v_mov_b32 v16, 0xbfb8aa3b
    v_mov_b32 v17, 0xbfb8aa3b
    v_mov_b32 v18, 1.0
    v_mov_b32 v19, 1.0
    v_lshlrev_b32 v56, 16, v120
    v_and_b32 v57, 0xffff0000, v120
    v_lshlrev_b32 v58, 16, v121
    v_and_b32 v59, 0xffff0000, v121
    v_lshlrev_b32 v60, 16, v122
    v_and_b32 v61, 0xffff0000, v122
    v_lshlrev_b32 v62, 16, v123
    v_and_b32 v63, 0xffff0000, v123
    v_lshlrev_b32 v64, 16, v124
    v_and_b32 v65, 0xffff0000, v124
    v_lshlrev_b32 v66, 16, v125
    v_and_b32 v67, 0xffff0000, v125
    v_lshlrev_b32 v68, 16, v126
    v_and_b32 v69, 0xffff0000, v126
    v_lshlrev_b32 v70, 16, v127
    v_and_b32 v71, 0xffff0000, v127
    v_pk_add_f32 v[128:129], v[128:129], v[56:57]
    v_pk_add_f32 v[130:131], v[130:131], v[58:59]
    v_pk_add_f32 v[132:133], v[132:133], v[60:61]
    v_pk_add_f32 v[134:135], v[134:135], v[62:63]
    v_pk_add_f32 v[136:137], v[136:137], v[64:65]
    v_pk_add_f32 v[138:139], v[138:139], v[66:67]
    v_pk_add_f32 v[140:141], v[140:141], v[68:69]
    v_pk_add_f32 v[142:143], v[142:143], v[70:71]
    v_pk_mul_f32 v[32:33], v[128:129], v[16:17]
    v_pk_mul_f32 v[34:35], v[130:131], v[16:17]
    v_pk_mul_f32 v[36:37], v[132:133], v[16:17]
    v_pk_mul_f32 v[38:39], v[134:135], v[16:17]
    v_pk_mul_f32 v[40:41], v[136:137], v[16:17]
    v_pk_mul_f32 v[42:43], v[138:139], v[16:17]
    v_pk_mul_f32 v[44:45], v[140:141], v[16:17]
    v_pk_mul_f32 v[46:47], v[142:143], v[16:17]
    v_exp_f32 v32, v32
    v_exp_f32 v33, v33
    v_exp_f32 v34, v34
    v_exp_f32 v35, v35
    v_exp_f32 v36, v36
    v_exp_f32 v37, v37
    v_exp_f32 v38, v38
    v_exp_f32 v39, v39
    v_exp_f32 v40, v40
    v_exp_f32 v41, v41
    v_exp_f32 v42, v42
    v_exp_f32 v43, v43
    v_exp_f32 v44, v44
    v_exp_f32 v45, v45
    v_exp_f32 v46, v46
    v_exp_f32 v47, v47
    v_lshlrev_b32 v56, 16, v112
    v_and_b32 v57, 0xffff0000, v112
    v_lshlrev_b32 v58, 16, v113
    v_and_b32 v59, 0xffff0000, v113
    v_lshlrev_b32 v60, 16, v114
    v_and_b32 v61, 0xffff0000, v114
    v_lshlrev_b32 v62, 16, v115
    v_and_b32 v63, 0xffff0000, v115
    v_lshlrev_b32 v64, 16, v116
    v_and_b32 v65, 0xffff0000, v116
    v_lshlrev_b32 v66, 16, v117
    v_and_b32 v67, 0xffff0000, v117
    v_lshlrev_b32 v68, 16, v118
    v_and_b32 v69, 0xffff0000, v118
    v_lshlrev_b32 v70, 16, v119
    v_and_b32 v71, 0xffff0000, v119
    v_pk_add_f32 v[32:33], v[32:33], v[18:19]
    v_pk_add_f32 v[34:35], v[34:35], v[18:19]
    v_pk_add_f32 v[36:37], v[36:37], v[18:19]
    v_pk_add_f32 v[38:39], v[38:39], v[18:19]
    v_pk_add_f32 v[40:41], v[40:41], v[18:19]
    v_pk_add_f32 v[42:43], v[42:43], v[18:19]
    v_pk_add_f32 v[44:45], v[44:45], v[18:19]
    v_pk_add_f32 v[46:47], v[46:47], v[18:19]
    v_rcp_f32 v32, v32
    v_rcp_f32 v33, v33
    v_rcp_f32 v34, v34
    v_rcp_f32 v35, v35
    v_rcp_f32 v36, v36
    v_rcp_f32 v37, v37
    v_rcp_f32 v38, v38
    v_rcp_f32 v39, v39
    v_rcp_f32 v40, v40
    v_rcp_f32 v41, v41
    v_rcp_f32 v42, v42
    v_rcp_f32 v43, v43
    v_rcp_f32 v44, v44
    v_rcp_f32 v45, v45
    v_rcp_f32 v46, v46
    v_rcp_f32 v47, v47
    s_nop 0
    v_pk_mul_f32 v[128:129], v[128:129], v[32:33]
    v_pk_mul_f32 v[130:131], v[130:131], v[34:35]
    v_pk_mul_f32 v[132:133], v[132:133], v[36:37]
    v_pk_mul_f32 v[134:135], v[134:135], v[38:39]
    v_pk_mul_f32 v[136:137], v[136:137], v[40:41]
    v_pk_mul_f32 v[138:139], v[138:139], v[42:43]
    v_pk_mul_f32 v[140:141], v[140:141], v[44:45]
    v_pk_mul_f32 v[142:143], v[142:143], v[46:47]
    v_pk_fma_f32 v[128:129], v[128:129], v[192:193], v[56:57]
    v_pk_fma_f32 v[130:131], v[130:131], v[194:195], v[58:59]
    v_pk_fma_f32 v[132:133], v[132:133], v[196:197], v[60:61]
    v_pk_fma_f32 v[134:135], v[134:135], v[198:199], v[62:63]
    v_pk_fma_f32 v[136:137], v[136:137], v[200:201], v[64:65]
    v_pk_fma_f32 v[138:139], v[138:139], v[202:203], v[66:67]
    v_pk_fma_f32 v[140:141], v[140:141], v[204:205], v[68:69]
    v_pk_fma_f32 v[142:143], v[142:143], v[206:207], v[70:71]
    v_cvt_pk_bf16_f32 v48, v128, v129
    v_cvt_pk_bf16_f32 v49, v130, v131
    v_cvt_pk_bf16_f32 v50, v132, v133
    v_cvt_pk_bf16_f32 v51, v134, v135
    v_cvt_pk_bf16_f32 v52, v136, v137
    v_cvt_pk_bf16_f32 v53, v138, v139
    v_cvt_pk_bf16_f32 v54, v140, v141
    v_cvt_pk_bf16_f32 v55, v142, v143
    buffer_store_dwordx2 v[48:49], v14, s[44:47], s64 offen offset:0
    buffer_store_dwordx2 v[50:51], v14, s[44:47], s64 offen offset:16
    buffer_store_dwordx2 v[52:53], v14, s[44:47], s64 offen offset:32
    buffer_store_dwordx2 v[54:55], v14, s[44:47], s64 offen offset:48
kD_done:
    s_endpgm
text_end_marker:
    s_endpgm
.section .rodata,"a"
.p2align 6
.amdhsa_kernel kA_kernel
  .amdhsa_next_free_vgpr 200
  .amdhsa_next_free_sgpr 96
  .amdhsa_accum_offset 200
  .amdhsa_group_segment_fixed_size 0
  .amdhsa_kernarg_size 88
  .amdhsa_user_sgpr_count 2
  .amdhsa_user_sgpr_kernarg_segment_ptr 1
  .amdhsa_system_sgpr_workgroup_id_x 1
  .amdhsa_float_denorm_mode_32 3
.end_amdhsa_kernel
.p2align 6
.amdhsa_kernel kB_kernel
  .amdhsa_next_free_vgpr 168
  .amdhsa_next_free_sgpr 96
  .amdhsa_accum_offset 168
  .amdhsa_group_segment_fixed_size 0
  .amdhsa_kernarg_size 88
  .amdhsa_user_sgpr_count 2
  .amdhsa_user_sgpr_kernarg_segment_ptr 1
  .amdhsa_system_sgpr_workgroup_id_x 1
  .amdhsa_float_denorm_mode_32 3
.end_amdhsa_kernel
.p2align 6
.amdhsa_kernel kC_kernel
  .amdhsa_next_free_vgpr 152
  .amdhsa_next_free_sgpr 96
  .amdhsa_accum_offset 152
  .amdhsa_group_segment_fixed_size 0
  .amdhsa_kernarg_size 88
  .amdhsa_user_sgpr_count 2
  .amdhsa_user_sgpr_kernarg_segment_ptr 1
  .amdhsa_system_sgpr_workgroup_id_x 1
  .amdhsa_float_denorm_mode_32 3
.end_amdhsa_kernel
.p2align 6
.amdhsa_kernel kD_kernel
  .amdhsa_next_free_vgpr 256
  .amdhsa_next_free_sgpr 96
  .amdhsa_accum_offset 256
  .amdhsa_group_segment_fixed_size 0
  .amdhsa_kernarg_size 88
  .amdhsa_user_sgpr_count 2
  .amdhsa_user_sgpr_kernarg_segment_ptr 1
  .amdhsa_system_sgpr_workgroup_id_x 1
  .amdhsa_float_denorm_mode_32 3
.end_amdhsa_kernel
```
